```python
import torch

def _softmax(x, axis=-1):
    return torch.softmax(x, dim=axis)

def _gelu(x):
    return torch.nn.functional.gelu(x, approximate='tanh')

def _silu(x):
    return torch.nn.functional.silu(x)

def _sigmoid(x):
    return torch.sigmoid(x)

def _layernorm(x, axis=-1, eps=1e-05):
    m = x.mean(dim=axis, keepdim=True)
    v = x.var(dim=axis, keepdim=True, unbiased=False)
    return (x - m) / torch.sqrt(v + eps)

def _scatter_add(tgt, idx, src, axis=0):
    return tgt.clone().index_add_(axis, idx, src)

def _segment_sum(src, seg, n):
    out = torch.zeros((n,) + src.shape[1:], dtype=src.dtype)
    return out.index_add_(0, seg, src)

def _pad(x, pw):
    flat = tuple((v for pair in reversed(pw) for v in pair))
    return torch.nn.functional.pad(x, flat)
kernel_name = 'parallel_sum__memory_aug_recurrent_mem_tr__geglu_ffn__prompt'

def setup_inputs():

    _w = lambda a: (lambda t: t.to(torch.bfloat16) if t.is_floating_point() else t)(torch.as_tensor(a))

    def _A_setup():
        B, S, Dm = (1, 2048, 512)
        H, Dh = (32, 128)
        M, seg = (8, 32)
        seg = min(seg, S)
        S = S // seg * seg
        return {'x': _w((lambda *s: torch.randn(*s, dtype=torch.bfloat16) * 0.05)(B, S, Dm)), 'mem0': _w((lambda *s: torch.randn(*s, dtype=torch.bfloat16) * 1.6)(B, M, Dm)), 'Wq': _w((lambda *s: torch.randn(*s, dtype=torch.bfloat16) * 0.8)(Dm, H, Dh) * Dm ** (-0.5)), 'Wk': _w((lambda *s: torch.randn(*s, dtype=torch.bfloat16) * 0.8)(Dm, H, Dh) * Dm ** (-0.5)), 'Wv': _w((lambda *s: torch.randn(*s, dtype=torch.bfloat16) * 1.6)(Dm, H, Dh) * Dm ** (-0.5)), 'Wo': _w((lambda *s: torch.randn(*s, dtype=torch.bfloat16) * 1.6)(H, Dh, Dm) * (H * Dh) ** (-0.5)), 'seg_len': seg}
    _A_in = _A_setup()

    def _B_setup():
        B, S, D, F = (1, 2048, 512, 1376)
        return {'x': _w((lambda *s: torch.randn(*s, dtype=torch.bfloat16) * 0.05)(B, S, D)), 'w_gate': _w((lambda *s: torch.randn(*s, dtype=torch.bfloat16) * 0.05)(D, F)), 'w_up': _w((lambda *s: torch.randn(*s, dtype=torch.bfloat16) * 0.05)(D, F)), 'w_down': _w((lambda *s: torch.randn(*s, dtype=torch.bfloat16) * 0.05)(F, D))}
    _B_in = _B_setup()
    return {'A_x': _A_in['x'], 'A_mem0': _A_in['mem0'], 'A_Wq': _A_in['Wq'], 'A_Wk': _A_in['Wk'], 'A_Wv': _A_in['Wv'], 'A_Wo': _A_in['Wo'], 'A_seg_len': _A_in['seg_len'], 'B_x': _B_in['x'], 'B_w_gate': _B_in['w_gate'], 'B_w_up': _B_in['w_up'], 'B_w_down': _B_in['w_down']}

def reference(A_x, A_mem0, A_Wq, A_Wk, A_Wv, A_Wo, A_seg_len, B_x, B_w_gate, B_w_up, B_w_down):

    def _A_ref(x, mem0, Wq, Wk, Wv, Wo, seg_len):
        B, S, Dm = x.shape
        H, Dh = (Wq.shape[1], Wq.shape[2])
        M = mem0.shape[1]
        scale = Dh ** (-0.5)
        n_seg = S // seg_len
        L = M + seg_len
        idx = torch.arange(L)
        mask = (idx[:, None] < M) | (idx[:, None] >= idx[None, :])
        mem = mem0
        outs = []
        for s in range(n_seg):
            xs = x[:, s * seg_len:(s + 1) * seg_len, :].clone()
            h = torch.concatenate([mem, xs], axis=1)
            q = torch.einsum('btd,dhe->bhte', h, Wq)
            k = torch.einsum('btd,dhe->bhte', h, Wk)
            v = torch.einsum('btd,dhe->bhte', h, Wv)
            scores = torch.einsum('bhqe,bhke->bhqk', q, k) * scale
            scores = torch.where(mask[None, None], scores, -1000000000.0)
            p = _softmax(scores, axis=-1)
            o = torch.einsum('bhqk,bhke->bhqe', p, v)
            o = torch.einsum('bhte,hed->btd', o, Wo)
            mem = o[:, :M, :].clone()
            outs.append(o[:, M:, :])
        return torch.concatenate(outs, axis=1)

    def _B_ref(x, w_gate, w_up, w_down):
        return _gelu(x @ w_gate) * (x @ w_up) @ w_down
    x = A_x
    xn = _layernorm(x, axis=-1)
    return x + _A_ref(xn, A_mem0, A_Wq, A_Wk, A_Wv, A_Wo, A_seg_len) + _B_ref(xn, B_w_gate, B_w_up, B_w_down)
```

```asm
; @launch kernel=parallel_sum__memory_aug_recurrent_mem_tr__geglu_ffn__prompt_kernel grid=(256,1,1) block=(256,1,1) lds=163840
.amdgcn_target "amdgcn-amd-amdhsa--gfx950"
.text
.globl parallel_sum__memory_aug_recurrent_mem_tr__geglu_ffn__prompt_kernel
.p2align 8
.type parallel_sum__memory_aug_recurrent_mem_tr__geglu_ffn__prompt_kernel,@function
parallel_sum__memory_aug_recurrent_mem_tr__geglu_ffn__prompt_kernel:
  s_cmp_ge_u32 s2, 256
  s_cbranch_scc1 L_end
  s_getpc_b64 s[6:7]
L_pc0:
  s_lshr_b32 s4, s2, 3
  s_and_b32 s4, s4, 3
  s_lshl_b32 s4, s4, 14
  v_lshlrev_b32 v2, 6, v0
  v_add_u32 v2, s4, v2
  v_min_u32 v2, L_end-L_pc0, v2
  global_load_dword v127, v2, s[6:7]
  s_load_dwordx4 s[4:7], s[0:1], 96
  s_load_dwordx16 s[64:79], s[0:1], 0
  s_getreg_b32 s3, hwreg(HW_REG_XCC_ID)
  s_and_b32 s3, s3, 0xf
  v_lshrrev_b32 v1, 6, v0
  s_nop 0
  v_readfirstlane_b32 s32, v1
  s_waitcnt lgkmcnt(0)
  s_mov_b32 s12, s4
  s_and_b32 s13, s5, 0xffff
  s_mov_b32 s14, 256
  s_mov_b32 s15, 0x20000
  s_mov_b32 s8, s6
  s_and_b32 s9, s7, 0xffff
  s_mov_b32 s10, 268435456
  s_mov_b32 s11, 0x20000
  s_and_b32 s3, s3, 7
  s_xor_b32 s3, s3, 3
  s_lshr_b32 s36, s2, 3
  s_lshl_b32 s94, s3, 5
  s_add_u32 s94, s94, s36
  s_mov_b32 s95, 0
  s_mov_b32 s96, s3
  s_cmp_lg_u32 s32, 0
  s_cbranch_scc1 L_first
  s_mov_b64 exec, 1
  s_lshr_b32 s36, s94, 5
  s_and_b32 s37, s94, 31
  s_mov_b32 s38, 0
L_claim:
  s_lshl_b32 s39, s36, 2
  s_cmp_eq_u32 s36, 0
  s_cselect_b32 s39, 128, s39
  v_mov_b32 v3, s39
  s_cbranch_scc0 L_claim2
  s_cmp_eq_u32 s96, 0
  s_cbranch_scc1 L_claim2
  v_mov_b32 v4, 1
  buffer_atomic_add v4, v3, s[12:15], 0 offen offset:4 sc0 sc1
  s_waitcnt vmcnt(0)
L_claim2:
  s_lshl_b32 s39, 1, s37
  v_mov_b32 v4, s39
  buffer_atomic_or v4, v3, s[12:15], 0 offen sc0 sc1
  s_waitcnt vmcnt(0)
  v_readfirstlane_b32 s39, v4
  s_nop 0
  s_bitcmp0_b32 s39, s37
  s_cbranch_scc1 L_claimed
  s_ff0_i32_b32 s37, s39
  s_cmp_ge_i32 s37, 0
  s_cbranch_scc1 L_claim
  s_mov_b32 s37, 0
  s_add_u32 s38, s38, 1
  s_add_u32 s36, s36, 1
  s_cmp_le_u32 s36, 7
  s_cselect_b32 s36, s36, 1
  s_cmp_ge_u32 s38, 8
  s_cselect_b32 s36, 0, s36
  s_cmp_le_u32 s38, 8
  s_cbranch_scc1 L_claim
  s_mov_b32 s36, 8
L_claimed:
  s_lshl_b32 s36, s36, 5
  s_add_u32 s36, s36, s37
  v_mov_b32 v3, 163836
  v_mov_b32 v4, s36
  ds_write_b32 v3, v4
  s_waitcnt lgkmcnt(0)
  s_mov_b64 exec, -1
L_first:
L_role:
  s_cmp_ge_u32 s94, 256
  s_cbranch_scc1 L_end
  v_mbcnt_lo_u32_b32 v0, -1, 0
  v_mbcnt_hi_u32_b32 v0, -1, v0
  s_lshr_b32 s3, s94, 5
  s_and_b32 s33, s94, 31
  s_lshl_b32 s91, s94, 9
  s_add_u32 s91, s91, 0x6000000
  s_cmp_lg_u32 s3, 0
  s_cbranch_scc1 L_worker
  s_load_dwordx4 s[16:19], s[0:1], 16
  s_load_dwordx4 s[24:27], s[0:1], 32
  s_load_dwordx2 s[4:5], s[0:1], 8
  v_and_b32 v20, 63, v0
  v_lshlrev_b32 v0, 4, v20
  s_mul_i32 s52, s32, 28672
  s_add_u32 s52, s52, 49152
  s_mul_i32 s53, s32, 12288
  v_bfe_u32 v21, v20, 4, 1
  v_bfe_u32 v22, v20, 3, 1
  v_bfe_u32 v23, v20, 2, 1
  v_bfe_u32 v24, v20, 1, 1
  v_and_b32 v25, 1, v20
  v_lshrrev_b32 v26, 5, v20
  v_lshlrev_b32 v27, 3, v21
  v_lshl_add_u32 v27, v22, 1, v27
  v_lshl_add_u32 v27, v23, 2, v27
  v_lshl_add_u32 v27, v24, 5, v27
  v_lshlrev_b32 v27, 13, v27
  v_lshl_add_u32 v27, v26, 5, v27
  v_lshl_add_u32 v32, v25, 4, v27
  v_lshlrev_b32 v27, 4, v22
  v_lshl_add_u32 v27, v21, 2, v27
  v_add_u32 v27, v27, v24
  v_lshlrev_b32 v27, 10, v27
  v_lshl_add_u32 v27, v26, 6, v27
  v_lshl_add_u32 v27, v23, 5, v27
  v_lshl_add_u32 v33, v25, 4, v27
  v_lshlrev_b32 v27, 3, v20
  v_add_u32 v34, s52, v27
  v_add_u32 v35, s53, v27
  s_lshl_b32 s36, s33, 8
  s_lshl_b32 s37, s32, 6
  s_and_b32 s37, s37, 0x80
  s_add_u32 s36, s36, s37
  s_lshl_b32 s37, s32, 1
  v_lshlrev_b32 v27, 1, v26
  v_lshl_add_u32 v27, v21, 2, v27
  v_lshl_add_u32 v27, v22, 5, v27
  v_lshlrev_b32 v27, 13, v27
  v_bfe_u32 v28, v20, 4, 2
  v_lshlrev_b32 v28, 1, v28
  v_and_b32 v29, 7, v20
  v_xor_b32 v28, v28, v29
  v_lshl_add_u32 v32, v28, 4, v27
  v_lshlrev_b32 v27, 10, v26
  v_bfe_u32 v28, v20, 2, 3
  v_lshl_add_u32 v27, v28, 7, v27
  v_and_b32 v28, 3, v20
  v_lshl_add_u32 v27, v28, 3, v27
  v_bfe_u32 v28, v20, 3, 2
  s_and_b32 s38, s37, 2
  v_xor_b32 v28, s38, v28
  v_lshl_add_u32 v29, v28, 5, v27
  v_xor_b32 v28, 1, v28
  v_lshl_add_u32 v30, v28, 5, v27
  s_xor_b32 s38, s32, 1
  s_mul_i32 s39, s38, 28672
  s_add_u32 s39, s39, 49152
  s_mul_i32 s38, s38, 12288
  v_add_u32 v66, s52, v29
  v_add_u32 v67, s52, v30
  v_add_u32 v68, s53, v29
  v_add_u32 v69, s53, v30
  v_add_u32 v70, s39, v29
  v_add_u32 v71, s39, v30
  v_add_u32 v72, s38, v29
  v_add_u32 v73, s38, v30
  s_xor_b32 s38, s37, 0
  s_lshl_b32 s38, s38, 19
  s_add_u32 s40, s38, s36
  s_xor_b32 s38, s37, 1
  s_lshl_b32 s38, s38, 19
  s_add_u32 s41, s38, s36
  s_xor_b32 s38, s37, 2
  s_lshl_b32 s38, s38, 19
  s_add_u32 s42, s38, s36
  s_xor_b32 s38, s37, 3
  s_lshl_b32 s38, s38, 19
  s_add_u32 s43, s38, s36
  s_xor_b32 s38, s37, 4
  s_lshl_b32 s38, s38, 19
  s_add_u32 s44, s38, s36
  s_xor_b32 s38, s37, 5
  s_lshl_b32 s38, s38, 19
  s_add_u32 s45, s38, s36
  s_xor_b32 s38, s37, 6
  s_lshl_b32 s38, s38, 19
  s_add_u32 s46, s38, s36
  s_xor_b32 s38, s37, 7
  s_lshl_b32 s38, s38, 19
  s_add_u32 s47, s38, s36
  s_lshl_b32 s36, s33, 17
  s_lshl_b32 s37, s32, 8
  s_add_u32 s36, s36, s37
  s_xor_b32 s38, s32, 0
  s_lshl_b32 s38, s38, 15
  s_add_u32 s48, s38, s36
  s_xor_b32 s38, s32, 1
  s_lshl_b32 s38, s38, 15
  s_add_u32 s49, s38, s36
  s_xor_b32 s38, s32, 2
  s_lshl_b32 s38, s38, 15
  s_add_u32 s50, s38, s36
  s_xor_b32 s38, s32, 3
  s_lshl_b32 s38, s38, 15
  s_add_u32 s51, s38, s36
  s_lshr_b32 s36, s33, 3
  s_lshl_b32 s36, s36, 4
  s_and_b32 s37, s32, 1
  s_lshl_b32 s37, s37, 3
  s_add_u32 s36, s36, s37
  s_and_b32 s39, s33, 7
  s_add_u32 s37, s36, s39
  s_lshl_b32 s61, s37, 7
  v_lshrrev_b32 v21, 4, v20
  v_bfe_u32 v22, v20, 2, 1
  v_lshl_add_u32 v21, v21, 1, v22
  v_lshlrev_b32 v23, 4, v21
  v_and_b32 v22, 3, v20
  v_lshl_add_u32 v23, v22, 2, v23
  v_add_u32 v4, s61, v23
  v_lshlrev_b32 v24, 10, v21
  v_lshl_add_u32 v24, v22, 1, v24
  s_lshl_b32 s36, s36, 4
  s_lshl_b32 s39, s39, 3
  s_add_u32 s39, s36, s39
  s_waitcnt lgkmcnt(0)
  s_mov_b32 s20, s18
  s_and_b32 s21, s19, 0xffff
  s_mov_b32 s22, 0x400000
  s_mov_b32 s23, 0x20000
  s_and_b32 s17, s17, 0xffff
  s_mov_b32 s18, 0x400000
  s_mov_b32 s19, 0x20000
  s_mov_b32 s28, s26
  s_and_b32 s29, s27, 0xffff
  s_mov_b32 s30, 0x400000
  s_mov_b32 s31, 0x20000
  s_and_b32 s25, s25, 0xffff
  s_mov_b32 s26, 0x400000
  s_mov_b32 s27, 0x20000
  s_mov_b32 s84, s4
  s_and_b32 s85, s5, 0xffff
  s_mov_b32 s86, 8192
  s_mov_b32 s87, 0x20000
  buffer_load_ushort v38, v24, s[84:87], s39 offen
  buffer_load_ushort v39, v24, s[84:87], s39 offen offset:64
  s_add_u32 m0, s52, 8192
  s_add_u32 s38, s40, 0
  buffer_load_dwordx4 v32, s[20:23], s38 offen  lds
  s_add_u32 m0, s52, 9216
  s_add_u32 s38, s40, 65536
  buffer_load_dwordx4 v32, s[20:23], s38 offen  lds
  s_add_u32 m0, s52, 10240
  s_add_u32 s38, s40, 8192
  buffer_load_dwordx4 v32, s[20:23], s38 offen  lds
  s_add_u32 m0, s52, 11264
  s_add_u32 s38, s40, 73728
  buffer_load_dwordx4 v32, s[20:23], s38 offen  lds
  s_add_u32 m0, s53, 0
  s_add_u32 s38, s40, 131072
  buffer_load_dwordx4 v32, s[20:23], s38 offen  lds
  s_add_u32 m0, s53, 1024
  s_add_u32 s38, s40, 196608
  buffer_load_dwordx4 v32, s[20:23], s38 offen  lds
  s_add_u32 m0, s53, 2048
  s_add_u32 s38, s40, 139264
  buffer_load_dwordx4 v32, s[20:23], s38 offen  lds
  s_add_u32 m0, s53, 3072
  s_add_u32 s38, s40, 204800
  buffer_load_dwordx4 v32, s[20:23], s38 offen  lds
  s_add_u32 m0, s52, 12288
  s_add_u32 s38, s41, 0
  buffer_load_dwordx4 v32, s[20:23], s38 offen  lds
  s_add_u32 m0, s52, 13312
  s_add_u32 s38, s41, 65536
  buffer_load_dwordx4 v32, s[20:23], s38 offen  lds
  s_add_u32 m0, s52, 14336
  s_add_u32 s38, s41, 8192
  buffer_load_dwordx4 v32, s[20:23], s38 offen  lds
  s_add_u32 m0, s52, 15360
  s_add_u32 s38, s41, 73728
  buffer_load_dwordx4 v32, s[20:23], s38 offen  lds
  s_add_u32 m0, s53, 4096
  s_add_u32 s38, s41, 131072
  buffer_load_dwordx4 v32, s[20:23], s38 offen  lds
  s_add_u32 m0, s53, 5120
  s_add_u32 s38, s41, 196608
  buffer_load_dwordx4 v32, s[20:23], s38 offen  lds
  s_add_u32 m0, s53, 6144
  s_add_u32 s38, s41, 139264
  buffer_load_dwordx4 v32, s[20:23], s38 offen  lds
  s_add_u32 m0, s53, 7168
  s_add_u32 s38, s41, 204800
  buffer_load_dwordx4 v32, s[20:23], s38 offen  lds
  s_cmp_lg_u32 s95, 0
  s_cbranch_scc1 c_conf
  s_mov_b32 s95, 1
  s_barrier
  v_mov_b32 v14, 163836
  ds_read_b32 v14, v14
  s_waitcnt lgkmcnt(0)
  v_readfirstlane_b32 s36, v14
  s_barrier
  s_cmp_eq_u32 s36, s94
  s_cbranch_scc1 c_conf
  s_mov_b32 s94, s36
  s_waitcnt vmcnt(0)
  s_barrier
  s_branch L_role
c_conf:
  s_mov_b32 s35, 4000000
  s_lshl_b32 s36, s32, 11
  v_add_u32 v7, s36, v0
  v_xor_b32 v8, 2048, v7
  v_xor_b32 v9, 4096, v7
  v_xor_b32 v10, 6144, v7
  s_add_u32 s54, s36, 458752
  s_mov_b32 s55, 466944
  s_mov_b32 s56, 524288
  s_cmp_ge_u32 s32, 2
  s_cselect_b32 s56, 0x20000000, s56
  v_add_u32 v11, s52, v0
  v_and_b32 v21, 8, v20
  v_cmp_eq_u32 vcc, 0, v21
  v_mov_b32 v22, 0xeeee
  v_mov_b32 v23, 0x4444
  v_cndmask_b32 v1, v22, v23, vcc
  s_mov_b32 s80, 0x00ff00ff
  s_mov_b32 s81, 0x00ff00ff
  v_lshrrev_b32 v21, 5, v20
  v_bfe_u32 v22, v20, 2, 2
  v_lshl_add_u32 v21, v21, 2, v22
  v_lshlrev_b32 v21, 12, v21
  v_bfe_u32 v22, v20, 4, 1
  v_lshl_add_u32 v21, v22, 6, v21
  v_and_b32 v22, 3, v20
  v_lshl_add_u32 v21, v22, 4, v21
  s_lshl_b32 s36, s32, 15
  v_add_u32 v21, s36, v21
  v_lshrrev_b32 v22, 12, v21
  v_mul_u32_u24 v22, 5, v22
  v_add_u32 v22, s33, v22
  v_and_b32 v22, 31, v22
  v_lshl_add_u32 v2, v22, 7, v21
  s_mov_b32 s60, 0
  s_mov_b32 s58, 1048576
  s_mov_b32 s59, 1179648
  s_and_b32 s36, s32, 1
  s_lshl_b32 s36, s36, 5
  s_add_u32 s36, s36, s33
  s_lshl_b32 s37, s36, 12
  s_add_u32 s62, s37, 1048576
  s_mov_b32 s63, s62
  s_lshr_b32 s38, s32, 1
  s_lshl_b32 s38, s38, 5
  s_add_u32 s38, s38, s33
  s_lshl_b32 s38, s38, 12
  s_and_b32 s39, s32, 1
  s_lshl_b32 s39, s39, 11
  s_add_u32 s38, s38, s39
  s_add_u32 s65, s38, 1048576
  s_lshl_b32 s38, s32, 12
  s_add_u32 s66, s38, 16384
  s_add_u32 s67, s38, 32768
  s_lshl_b32 s39, s33, 20
  s_add_u32 s38, s38, s39
  s_add_u32 s57, s38, 33554432
  s_mov_b32 s68, 1040356334
  v_lshrrev_b32 v21, 5, v20
  v_and_b32 v22, 15, v20
  v_lshl_add_u32 v21, v21, 4, v22
  v_lshlrev_b32 v21, 4, v21
  v_bfe_u32 v22, v20, 4, 1
  v_lshl_add_u32 v21, v22, 3, v21
  s_lshl_b32 s38, s32, 11
  v_add_u32 v5, s38, v21
  v_lshrrev_b32 v21, 2, v20
  v_lshlrev_b32 v21, 4, v21
  v_and_b32 v22, 1, v20
  v_lshl_add_u32 v6, v22, 3, v21
  v_and_b32 v21, 3, v20
  v_mov_b32 v22, 0
  v_mov_b32 v23, 0x3f80
  v_cmp_eq_u32 vcc, 0, v21
  s_nop 1
  v_cndmask_b32 v22, v22, v23, vcc
  v_mov_b32 v23, 0x3f800000
  v_cmp_eq_u32 vcc, 1, v21
  s_nop 1
  v_cndmask_b32 v3, v22, v23, vcc
  s_mov_b32 s72, 0x0f0f0f0f
  s_mov_b32 s73, 0x0f0f0f0f
  s_mov_b32 s74, 0xf0f0f0f0
  s_mov_b32 s75, 0xf0f0f0f0
  s_mov_b32 s82, -1
  s_mov_b32 s83, 0
  s_waitcnt vmcnt(16)
  v_lshl_or_b32 v15, v39, 16, v38
  v_mov_b32 v28, -1
  v_mov_b32 v29, -1
  v_mov_b32 v30, -1
  v_mov_b32 v31, -1
  v_lshrrev_b32 v21, 3, v20
  v_lshlrev_b32 v21, 13, v21
  v_and_b32 v22, 7, v20
  v_lshl_add_u32 v21, v22, 4, v21
  v_add_u32 v21, s61, v21
  s_waitcnt vmcnt(12)
  s_waitcnt lgkmcnt(0)
  s_barrier
  s_add_u32 m0, s53, 8192
  s_add_u32 s38, s44, 0
  buffer_load_dwordx4 v32, s[20:23], s38 offen  lds
  s_add_u32 m0, s53, 9216
  s_add_u32 s38, s44, 65536
  buffer_load_dwordx4 v32, s[20:23], s38 offen  lds
  s_add_u32 m0, s53, 10240
  s_add_u32 s38, s44, 8192
  buffer_load_dwordx4 v32, s[20:23], s38 offen  lds
  s_add_u32 m0, s53, 11264
  s_add_u32 s38, s44, 73728
  buffer_load_dwordx4 v32, s[20:23], s38 offen  lds
  s_add_u32 m0, s52, 16384
  s_add_u32 s38, s44, 131072
  buffer_load_dwordx4 v32, s[20:23], s38 offen  lds
  s_add_u32 m0, s52, 17408
  s_add_u32 s38, s44, 196608
  buffer_load_dwordx4 v32, s[20:23], s38 offen  lds
  s_add_u32 m0, s52, 18432
  s_add_u32 s38, s44, 139264
  buffer_load_dwordx4 v32, s[20:23], s38 offen  lds
  s_add_u32 m0, s52, 19456
  s_add_u32 s38, s44, 204800
  buffer_load_dwordx4 v32, s[20:23], s38 offen  lds
  s_add_u32 m0, s52, 20480
  s_add_u32 s38, s45, 0
  buffer_load_dwordx4 v32, s[20:23], s38 offen  lds
  s_add_u32 m0, s52, 21504
  s_add_u32 s38, s45, 65536
  buffer_load_dwordx4 v32, s[20:23], s38 offen  lds
  s_add_u32 m0, s52, 22528
  s_add_u32 s38, s45, 8192
  buffer_load_dwordx4 v32, s[20:23], s38 offen  lds
  s_add_u32 m0, s52, 23552
  s_add_u32 s38, s45, 73728
  buffer_load_dwordx4 v32, s[20:23], s38 offen  lds
  ds_read_b64_tr_b16 v[40:41], v66 offset:8192
  ds_read_b64_tr_b16 v[42:43], v66 offset:10240
  ds_read_b64_tr_b16 v[48:49], v67 offset:8192
  ds_read_b64_tr_b16 v[50:51], v67 offset:10240
  ds_read_b64_tr_b16 a[128:129], v70 offset:8192
  ds_read_b64_tr_b16 a[130:131], v70 offset:10240
  ds_read_b64_tr_b16 a[136:137], v71 offset:8192
  ds_read_b64_tr_b16 a[138:139], v71 offset:10240
  s_waitcnt vmcnt(20)
  s_waitcnt lgkmcnt(0)
  s_barrier
  s_add_u32 m0, s52, 24576
  s_add_u32 s38, s45, 131072
  buffer_load_dwordx4 v32, s[20:23], s38 offen  lds
  s_add_u32 m0, s52, 25600
  s_add_u32 s38, s45, 196608
  buffer_load_dwordx4 v32, s[20:23], s38 offen  lds
  s_add_u32 m0, s52, 26624
  s_add_u32 s38, s45, 139264
  buffer_load_dwordx4 v32, s[20:23], s38 offen  lds
  s_add_u32 m0, s52, 27648
  s_add_u32 s38, s45, 204800
  buffer_load_dwordx4 v32, s[20:23], s38 offen  lds
  ds_read_b64_tr_b16 v[44:45], v68 offset:0
  ds_read_b64_tr_b16 v[46:47], v68 offset:2048
  ds_read_b64_tr_b16 v[52:53], v69 offset:0
  ds_read_b64_tr_b16 v[54:55], v69 offset:2048
  ds_read_b64_tr_b16 a[132:133], v72 offset:0
  ds_read_b64_tr_b16 a[134:135], v72 offset:2048
  ds_read_b64_tr_b16 a[140:141], v73 offset:0
  ds_read_b64_tr_b16 a[142:143], v73 offset:2048
  s_waitcnt lgkmcnt(0)
  ds_write_b128 v11, v[40:43] offset:8192
  ds_write_b128 v11, v[44:47] offset:9216
  ds_write_b128 v11, v[48:51] offset:10240
  ds_write_b128 v11, v[52:55] offset:11264
  s_waitcnt lgkmcnt(0)
  s_waitcnt vmcnt(20)
  s_waitcnt lgkmcnt(0)
  s_barrier
  s_add_u32 m0, s52, 0
  s_add_u32 s38, s40, 0
  buffer_load_dwordx4 v32, s[24:27], s38 offen  lds
  s_add_u32 m0, s52, 1024
  s_add_u32 s38, s40, 65536
  buffer_load_dwordx4 v32, s[24:27], s38 offen  lds
  s_add_u32 m0, s52, 2048
  s_add_u32 s38, s40, 8192
  buffer_load_dwordx4 v32, s[24:27], s38 offen  lds
  s_add_u32 m0, s52, 3072
  s_add_u32 s38, s40, 73728
  buffer_load_dwordx4 v32, s[24:27], s38 offen  lds
  ds_read_b64_tr_b16 v[40:41], v66 offset:12288
  ds_read_b64_tr_b16 v[42:43], v66 offset:14336
  ds_read_b64_tr_b16 v[48:49], v67 offset:12288
  ds_read_b64_tr_b16 v[50:51], v67 offset:14336
  ds_read_b64_tr_b16 a[144:145], v70 offset:12288
  ds_read_b64_tr_b16 a[146:147], v70 offset:14336
  ds_read_b64_tr_b16 a[152:153], v71 offset:12288
  ds_read_b64_tr_b16 a[154:155], v71 offset:14336
  s_waitcnt vmcnt(20)
  s_waitcnt lgkmcnt(0)
  s_barrier
  s_add_u32 m0, s53, 0
  s_add_u32 s38, s40, 131072
  buffer_load_dwordx4 v32, s[24:27], s38 offen  lds
  s_add_u32 m0, s53, 1024
  s_add_u32 s38, s40, 196608
  buffer_load_dwordx4 v32, s[24:27], s38 offen  lds
  s_add_u32 m0, s53, 2048
  s_add_u32 s38, s40, 139264
  buffer_load_dwordx4 v32, s[24:27], s38 offen  lds
  s_add_u32 m0, s53, 3072
  s_add_u32 s38, s40, 204800
  buffer_load_dwordx4 v32, s[24:27], s38 offen  lds
  ds_read_b64_tr_b16 v[44:45], v68 offset:4096
  ds_read_b64_tr_b16 v[46:47], v68 offset:6144
  ds_read_b64_tr_b16 v[52:53], v69 offset:4096
  ds_read_b64_tr_b16 v[54:55], v69 offset:6144
  ds_read_b64_tr_b16 a[148:149], v72 offset:4096
  ds_read_b64_tr_b16 a[150:151], v72 offset:6144
  ds_read_b64_tr_b16 a[156:157], v73 offset:4096
  ds_read_b64_tr_b16 a[158:159], v73 offset:6144
  s_waitcnt lgkmcnt(0)
  ds_write_b128 v11, v[40:43] offset:12288
  ds_write_b128 v11, v[44:47] offset:13312
  ds_write_b128 v11, v[48:51] offset:14336
  ds_write_b128 v11, v[52:55] offset:15360
  s_waitcnt lgkmcnt(0)
  s_waitcnt vmcnt(20)
  s_waitcnt lgkmcnt(0)
  s_barrier
  s_add_u32 m0, s52, 4096
  s_add_u32 s38, s41, 0
  buffer_load_dwordx4 v32, s[24:27], s38 offen  lds
  s_add_u32 m0, s52, 5120
  s_add_u32 s38, s41, 65536
  buffer_load_dwordx4 v32, s[24:27], s38 offen  lds
  s_add_u32 m0, s52, 6144
  s_add_u32 s38, s41, 8192
  buffer_load_dwordx4 v32, s[24:27], s38 offen  lds
  s_add_u32 m0, s52, 7168
  s_add_u32 s38, s41, 73728
  buffer_load_dwordx4 v32, s[24:27], s38 offen  lds
  ds_read_b64_tr_b16 a[160:161], v68 offset:8192
  ds_read_b64_tr_b16 a[162:163], v68 offset:10240
  ds_read_b64_tr_b16 a[168:169], v69 offset:8192
  ds_read_b64_tr_b16 a[170:171], v69 offset:10240
  ds_read_b64_tr_b16 a[192:193], v72 offset:8192
  ds_read_b64_tr_b16 a[194:195], v72 offset:10240
  ds_read_b64_tr_b16 a[200:201], v73 offset:8192
  ds_read_b64_tr_b16 a[202:203], v73 offset:10240
  s_waitcnt vmcnt(20)
  s_waitcnt lgkmcnt(0)
  s_barrier
  s_add_u32 m0, s53, 4096
  s_add_u32 s38, s41, 131072
  buffer_load_dwordx4 v32, s[24:27], s38 offen  lds
  s_add_u32 m0, s53, 5120
  s_add_u32 s38, s41, 196608
  buffer_load_dwordx4 v32, s[24:27], s38 offen  lds
  s_add_u32 m0, s53, 6144
  s_add_u32 s38, s41, 139264
  buffer_load_dwordx4 v32, s[24:27], s38 offen  lds
  s_add_u32 m0, s53, 7168
  s_add_u32 s38, s41, 204800
  buffer_load_dwordx4 v32, s[24:27], s38 offen  lds
  ds_read_b64_tr_b16 a[164:165], v66 offset:16384
  ds_read_b64_tr_b16 a[166:167], v66 offset:18432
  ds_read_b64_tr_b16 a[172:173], v67 offset:16384
  ds_read_b64_tr_b16 a[174:175], v67 offset:18432
  ds_read_b64_tr_b16 a[196:197], v70 offset:16384
  ds_read_b64_tr_b16 a[198:199], v70 offset:18432
  ds_read_b64_tr_b16 a[204:205], v71 offset:16384
  ds_read_b64_tr_b16 a[206:207], v71 offset:18432
  s_waitcnt vmcnt(20)
  s_waitcnt lgkmcnt(0)
  s_barrier
  s_add_u32 m0, s53, 8192
  s_add_u32 s38, s44, 0
  buffer_load_dwordx4 v32, s[24:27], s38 offen  lds
  s_add_u32 m0, s53, 9216
  s_add_u32 s38, s44, 65536
  buffer_load_dwordx4 v32, s[24:27], s38 offen  lds
  s_add_u32 m0, s53, 10240
  s_add_u32 s38, s44, 8192
  buffer_load_dwordx4 v32, s[24:27], s38 offen  lds
  s_add_u32 m0, s53, 11264
  s_add_u32 s38, s44, 73728
  buffer_load_dwordx4 v32, s[24:27], s38 offen  lds
  ds_read_b64_tr_b16 a[176:177], v66 offset:20480
  ds_read_b64_tr_b16 a[178:179], v66 offset:22528
  ds_read_b64_tr_b16 a[184:185], v67 offset:20480
  ds_read_b64_tr_b16 a[186:187], v67 offset:22528
  ds_read_b64_tr_b16 a[208:209], v70 offset:20480
  ds_read_b64_tr_b16 a[210:211], v70 offset:22528
  ds_read_b64_tr_b16 a[216:217], v71 offset:20480
  ds_read_b64_tr_b16 a[218:219], v71 offset:22528
  s_waitcnt vmcnt(20)
  s_waitcnt lgkmcnt(0)
  s_barrier
  s_add_u32 m0, s52, 16384
  s_add_u32 s38, s44, 131072
  buffer_load_dwordx4 v32, s[24:27], s38 offen  lds
  s_add_u32 m0, s52, 17408
  s_add_u32 s38, s44, 196608
  buffer_load_dwordx4 v32, s[24:27], s38 offen  lds
  s_add_u32 m0, s52, 18432
  s_add_u32 s38, s44, 139264
  buffer_load_dwordx4 v32, s[24:27], s38 offen  lds
  s_add_u32 m0, s52, 19456
  s_add_u32 s38, s44, 204800
  buffer_load_dwordx4 v32, s[24:27], s38 offen  lds
  ds_read_b64_tr_b16 a[180:181], v66 offset:24576
  ds_read_b64_tr_b16 a[182:183], v66 offset:26624
  ds_read_b64_tr_b16 a[188:189], v67 offset:24576
  ds_read_b64_tr_b16 a[190:191], v67 offset:26624
  ds_read_b64_tr_b16 a[212:213], v70 offset:24576
  ds_read_b64_tr_b16 a[214:215], v70 offset:26624
  ds_read_b64_tr_b16 a[220:221], v71 offset:24576
  ds_read_b64_tr_b16 a[222:223], v71 offset:26624
  s_waitcnt vmcnt(20)
  s_waitcnt lgkmcnt(0)
  s_barrier
  s_add_u32 m0, s52, 20480
  s_add_u32 s38, s45, 0
  buffer_load_dwordx4 v32, s[24:27], s38 offen  lds
  s_add_u32 m0, s52, 21504
  s_add_u32 s38, s45, 65536
  buffer_load_dwordx4 v32, s[24:27], s38 offen  lds
  s_add_u32 m0, s52, 22528
  s_add_u32 s38, s45, 8192
  buffer_load_dwordx4 v32, s[24:27], s38 offen  lds
  s_add_u32 m0, s52, 23552
  s_add_u32 s38, s45, 73728
  buffer_load_dwordx4 v32, s[24:27], s38 offen  lds
  ds_read_b64_tr_b16 v[40:41], v66 offset:0
  ds_read_b64_tr_b16 v[42:43], v66 offset:2048
  ds_read_b64_tr_b16 v[48:49], v67 offset:0
  ds_read_b64_tr_b16 v[50:51], v67 offset:2048
  ds_read_b64_tr_b16 a[224:225], v70 offset:0
  ds_read_b64_tr_b16 a[226:227], v70 offset:2048
  ds_read_b64_tr_b16 a[232:233], v71 offset:0
  ds_read_b64_tr_b16 a[234:235], v71 offset:2048
  s_waitcnt vmcnt(20)
  s_waitcnt lgkmcnt(0)
  s_barrier
  s_add_u32 m0, s52, 24576
  s_add_u32 s38, s45, 131072
  buffer_load_dwordx4 v32, s[24:27], s38 offen  lds
  s_add_u32 m0, s52, 25600
  s_add_u32 s38, s45, 196608
  buffer_load_dwordx4 v32, s[24:27], s38 offen  lds
  s_add_u32 m0, s52, 26624
  s_add_u32 s38, s45, 139264
  buffer_load_dwordx4 v32, s[24:27], s38 offen  lds
  s_add_u32 m0, s52, 27648
  s_add_u32 s38, s45, 204800
  buffer_load_dwordx4 v32, s[24:27], s38 offen  lds
  ds_read_b64_tr_b16 v[44:45], v68 offset:0
  ds_read_b64_tr_b16 v[46:47], v68 offset:2048
  ds_read_b64_tr_b16 v[52:53], v69 offset:0
  ds_read_b64_tr_b16 v[54:55], v69 offset:2048
  ds_read_b64_tr_b16 a[228:229], v72 offset:0
  ds_read_b64_tr_b16 a[230:231], v72 offset:2048
  ds_read_b64_tr_b16 a[236:237], v73 offset:0
  ds_read_b64_tr_b16 a[238:239], v73 offset:2048
  s_waitcnt lgkmcnt(0)
  ds_write_b128 v11, v[40:43] offset:0
  ds_write_b128 v11, v[44:47] offset:1024
  ds_write_b128 v11, v[48:51] offset:2048
  ds_write_b128 v11, v[52:55] offset:3072
  s_waitcnt lgkmcnt(0)
  s_waitcnt vmcnt(20)
  s_waitcnt lgkmcnt(0)
  s_barrier
  s_add_u32 m0, s53, 0
  s_add_u32 s38, s40, 0
  buffer_load_dwordx4 v32, s[16:19], s38 offen  lds
  s_add_u32 m0, s53, 1024
  s_add_u32 s38, s40, 65536
  buffer_load_dwordx4 v32, s[16:19], s38 offen  lds
  s_add_u32 m0, s53, 2048
  s_add_u32 s38, s40, 8192
  buffer_load_dwordx4 v32, s[16:19], s38 offen  lds
  s_add_u32 m0, s53, 3072
  s_add_u32 s38, s40, 73728
  buffer_load_dwordx4 v32, s[16:19], s38 offen  lds
  ds_read_b64_tr_b16 v[40:41], v66 offset:4096
  ds_read_b64_tr_b16 v[42:43], v66 offset:6144
  ds_read_b64_tr_b16 v[48:49], v67 offset:4096
  ds_read_b64_tr_b16 v[50:51], v67 offset:6144
  ds_read_b64_tr_b16 a[240:241], v70 offset:4096
  ds_read_b64_tr_b16 a[242:243], v70 offset:6144
  ds_read_b64_tr_b16 a[248:249], v71 offset:4096
  ds_read_b64_tr_b16 a[250:251], v71 offset:6144
  s_waitcnt vmcnt(20)
  s_waitcnt lgkmcnt(0)
  s_barrier
  ds_read_b64_tr_b16 v[44:45], v68 offset:4096
  ds_read_b64_tr_b16 v[46:47], v68 offset:6144
  ds_read_b64_tr_b16 v[52:53], v69 offset:4096
  ds_read_b64_tr_b16 v[54:55], v69 offset:6144
  ds_read_b64_tr_b16 a[244:245], v72 offset:4096
  ds_read_b64_tr_b16 a[246:247], v72 offset:6144
  ds_read_b64_tr_b16 a[252:253], v73 offset:4096
  ds_read_b64_tr_b16 a[254:255], v73 offset:6144
  s_waitcnt lgkmcnt(0)
  ds_write_b128 v11, v[40:43] offset:4096
  ds_write_b128 v11, v[44:47] offset:5120
  ds_write_b128 v11, v[48:51] offset:6144
  ds_write_b128 v11, v[52:55] offset:7168
  s_waitcnt lgkmcnt(0)
  s_waitcnt vmcnt(16)
  s_waitcnt lgkmcnt(0)
  s_barrier
  s_add_u32 m0, s53, 4096
  s_add_u32 s38, s40, 131072
  buffer_load_dwordx4 v32, s[16:19], s38 offen  lds
  s_add_u32 m0, s53, 5120
  s_add_u32 s38, s40, 196608
  buffer_load_dwordx4 v32, s[16:19], s38 offen  lds
  s_add_u32 m0, s53, 6144
  s_add_u32 s38, s40, 139264
  buffer_load_dwordx4 v32, s[16:19], s38 offen  lds
  s_add_u32 m0, s53, 7168
  s_add_u32 s38, s40, 204800
  buffer_load_dwordx4 v32, s[16:19], s38 offen  lds
  ds_read_b64_tr_b16 v[112:113], v68 offset:8192
  ds_read_b64_tr_b16 v[114:115], v68 offset:10240
  ds_read_b64_tr_b16 v[120:121], v69 offset:8192
  ds_read_b64_tr_b16 v[122:123], v69 offset:10240
  ds_read_b64_tr_b16 v[144:145], v72 offset:8192
  ds_read_b64_tr_b16 v[146:147], v72 offset:10240
  ds_read_b64_tr_b16 v[152:153], v73 offset:8192
  ds_read_b64_tr_b16 v[154:155], v73 offset:10240
  s_waitcnt vmcnt(16)
  s_waitcnt lgkmcnt(0)
  s_barrier
  s_add_u32 m0, s53, 8192
  s_add_u32 s38, s41, 0
  buffer_load_dwordx4 v32, s[16:19], s38 offen  lds
  s_add_u32 m0, s53, 9216
  s_add_u32 s38, s41, 65536
  buffer_load_dwordx4 v32, s[16:19], s38 offen  lds
  s_add_u32 m0, s53, 10240
  s_add_u32 s38, s41, 8192
  buffer_load_dwordx4 v32, s[16:19], s38 offen  lds
  s_add_u32 m0, s53, 11264
  s_add_u32 s38, s41, 73728
  buffer_load_dwordx4 v32, s[16:19], s38 offen  lds
  ds_read_b64_tr_b16 v[116:117], v66 offset:16384
  ds_read_b64_tr_b16 v[118:119], v66 offset:18432
  ds_read_b64_tr_b16 v[124:125], v67 offset:16384
  ds_read_b64_tr_b16 v[126:127], v67 offset:18432
  ds_read_b64_tr_b16 v[148:149], v70 offset:16384
  ds_read_b64_tr_b16 v[150:151], v70 offset:18432
  ds_read_b64_tr_b16 v[156:157], v71 offset:16384
  ds_read_b64_tr_b16 v[158:159], v71 offset:18432
  s_waitcnt vmcnt(16)
  s_waitcnt lgkmcnt(0)
  s_barrier
  s_add_u32 m0, s52, 16384
  s_add_u32 s38, s41, 131072
  buffer_load_dwordx4 v32, s[16:19], s38 offen  lds
  s_add_u32 m0, s52, 17408
  s_add_u32 s38, s41, 196608
  buffer_load_dwordx4 v32, s[16:19], s38 offen  lds
  s_add_u32 m0, s52, 18432
  s_add_u32 s38, s41, 139264
  buffer_load_dwordx4 v32, s[16:19], s38 offen  lds
  s_add_u32 m0, s52, 19456
  s_add_u32 s38, s41, 204800
  buffer_load_dwordx4 v32, s[16:19], s38 offen  lds
  ds_read_b64_tr_b16 v[128:129], v66 offset:20480
  ds_read_b64_tr_b16 v[130:131], v66 offset:22528
  ds_read_b64_tr_b16 v[136:137], v67 offset:20480
  ds_read_b64_tr_b16 v[138:139], v67 offset:22528
  ds_read_b64_tr_b16 v[160:161], v70 offset:20480
  ds_read_b64_tr_b16 v[162:163], v70 offset:22528
  ds_read_b64_tr_b16 v[168:169], v71 offset:20480
  ds_read_b64_tr_b16 v[170:171], v71 offset:22528
  s_waitcnt vmcnt(16)
  s_waitcnt lgkmcnt(0)
  s_barrier
  s_add_u32 m0, s52, 20480
  s_add_u32 s38, s44, 0
  buffer_load_dwordx4 v32, s[16:19], s38 offen  lds
  s_add_u32 m0, s52, 21504
  s_add_u32 s38, s44, 65536
  buffer_load_dwordx4 v32, s[16:19], s38 offen  lds
  s_add_u32 m0, s52, 22528
  s_add_u32 s38, s44, 8192
  buffer_load_dwordx4 v32, s[16:19], s38 offen  lds
  s_add_u32 m0, s52, 23552
  s_add_u32 s38, s44, 73728
  buffer_load_dwordx4 v32, s[16:19], s38 offen  lds
  ds_read_b64_tr_b16 v[132:133], v66 offset:24576
  ds_read_b64_tr_b16 v[134:135], v66 offset:26624
  ds_read_b64_tr_b16 v[140:141], v67 offset:24576
  ds_read_b64_tr_b16 v[142:143], v67 offset:26624
  ds_read_b64_tr_b16 v[164:165], v70 offset:24576
  ds_read_b64_tr_b16 v[166:167], v70 offset:26624
  ds_read_b64_tr_b16 v[172:173], v71 offset:24576
  ds_read_b64_tr_b16 v[174:175], v71 offset:26624
  v_mov_b32 v56, 128
  buffer_load_dwordx2 v[58:59], v56, s[12:15], 0 offen sc1
  buffer_load_dword v60, v56, s[12:15], 0 offen offset:64 sc1
  s_waitcnt vmcnt(16)
  s_waitcnt lgkmcnt(0)
  s_barrier
  s_add_u32 m0, s52, 24576
  s_add_u32 s38, s44, 131072
  buffer_load_dwordx4 v32, s[16:19], s38 offen  lds
  s_add_u32 m0, s52, 25600
  s_add_u32 s38, s44, 196608
  buffer_load_dwordx4 v32, s[16:19], s38 offen  lds
  s_add_u32 m0, s52, 26624
  s_add_u32 s38, s44, 139264
  buffer_load_dwordx4 v32, s[16:19], s38 offen  lds
  s_add_u32 m0, s52, 27648
  s_add_u32 s38, s44, 204800
  buffer_load_dwordx4 v32, s[16:19], s38 offen  lds
  ds_read_b64_tr_b16 a[0:1], v68 offset:0
  ds_read_b64_tr_b16 a[2:3], v68 offset:2048
  ds_read_b64_tr_b16 a[8:9], v69 offset:0
  ds_read_b64_tr_b16 a[10:11], v69 offset:2048
  ds_read_b64_tr_b16 a[32:33], v72 offset:0
  ds_read_b64_tr_b16 a[34:35], v72 offset:2048
  ds_read_b64_tr_b16 a[40:41], v73 offset:0
  ds_read_b64_tr_b16 a[42:43], v73 offset:2048
  s_waitcnt vmcnt(16)
  s_waitcnt lgkmcnt(0)
  s_barrier
  s_add_u32 m0, s53, 0
  s_add_u32 s38, s45, 0
  buffer_load_dwordx4 v32, s[16:19], s38 offen  lds
  s_add_u32 m0, s53, 1024
  s_add_u32 s38, s45, 65536
  buffer_load_dwordx4 v32, s[16:19], s38 offen  lds
  s_add_u32 m0, s53, 2048
  s_add_u32 s38, s45, 8192
  buffer_load_dwordx4 v32, s[16:19], s38 offen  lds
  s_add_u32 m0, s53, 3072
  s_add_u32 s38, s45, 73728
  buffer_load_dwordx4 v32, s[16:19], s38 offen  lds
  ds_read_b64_tr_b16 a[4:5], v68 offset:4096
  ds_read_b64_tr_b16 a[6:7], v68 offset:6144
  ds_read_b64_tr_b16 a[12:13], v69 offset:4096
  ds_read_b64_tr_b16 a[14:15], v69 offset:6144
  ds_read_b64_tr_b16 a[36:37], v72 offset:4096
  ds_read_b64_tr_b16 a[38:39], v72 offset:6144
  ds_read_b64_tr_b16 a[44:45], v73 offset:4096
  ds_read_b64_tr_b16 a[46:47], v73 offset:6144
  s_waitcnt vmcnt(16)
  s_waitcnt lgkmcnt(0)
  s_barrier
  s_add_u32 m0, s53, 4096
  s_add_u32 s38, s45, 131072
  buffer_load_dwordx4 v32, s[16:19], s38 offen  lds
  s_add_u32 m0, s53, 5120
  s_add_u32 s38, s45, 196608
  buffer_load_dwordx4 v32, s[16:19], s38 offen  lds
  s_add_u32 m0, s53, 6144
  s_add_u32 s38, s45, 139264
  buffer_load_dwordx4 v32, s[16:19], s38 offen  lds
  s_add_u32 m0, s53, 7168
  s_add_u32 s38, s45, 204800
  buffer_load_dwordx4 v32, s[16:19], s38 offen  lds
  ds_read_b64_tr_b16 a[16:17], v68 offset:8192
  ds_read_b64_tr_b16 a[18:19], v68 offset:10240
  ds_read_b64_tr_b16 a[24:25], v69 offset:8192
  ds_read_b64_tr_b16 a[26:27], v69 offset:10240
  ds_read_b64_tr_b16 a[48:49], v72 offset:8192
  ds_read_b64_tr_b16 a[50:51], v72 offset:10240
  ds_read_b64_tr_b16 a[56:57], v73 offset:8192
  ds_read_b64_tr_b16 a[58:59], v73 offset:10240
  s_waitcnt vmcnt(16)
  s_waitcnt lgkmcnt(0)
  s_barrier
  s_add_u32 m0, s53, 8192
  s_add_u32 s38, s48, 0
  buffer_load_dwordx4 v33, s[28:31], s38 offen  lds
  s_add_u32 m0, s53, 9216
  s_add_u32 s38, s48, 2048
  buffer_load_dwordx4 v33, s[28:31], s38 offen  lds
  s_add_u32 m0, s53, 10240
  s_add_u32 s38, s48, 8192
  buffer_load_dwordx4 v33, s[28:31], s38 offen  lds
  s_add_u32 m0, s53, 11264
  s_add_u32 s38, s48, 10240
  buffer_load_dwordx4 v33, s[28:31], s38 offen  lds
  ds_read_b64_tr_b16 a[20:21], v66 offset:16384
  ds_read_b64_tr_b16 a[22:23], v66 offset:18432
  ds_read_b64_tr_b16 a[28:29], v67 offset:16384
  ds_read_b64_tr_b16 a[30:31], v67 offset:18432
  ds_read_b64_tr_b16 a[52:53], v70 offset:16384
  ds_read_b64_tr_b16 a[54:55], v70 offset:18432
  ds_read_b64_tr_b16 a[60:61], v71 offset:16384
  ds_read_b64_tr_b16 a[62:63], v71 offset:18432
  s_waitcnt vmcnt(16)
  s_waitcnt lgkmcnt(0)
  s_barrier
  ds_read_b64_tr_b16 a[64:65], v66 offset:20480
  ds_read_b64_tr_b16 a[66:67], v66 offset:22528
  ds_read_b64_tr_b16 a[72:73], v67 offset:20480
  ds_read_b64_tr_b16 a[74:75], v67 offset:22528
  ds_read_b64_tr_b16 a[96:97], v70 offset:20480
  ds_read_b64_tr_b16 a[98:99], v70 offset:22528
  ds_read_b64_tr_b16 a[104:105], v71 offset:20480
  ds_read_b64_tr_b16 a[106:107], v71 offset:22528
  s_waitcnt vmcnt(12)
  s_waitcnt lgkmcnt(0)
  s_barrier
  ds_read_b64_tr_b16 a[68:69], v66 offset:24576
  ds_read_b64_tr_b16 a[70:71], v66 offset:26624
  ds_read_b64_tr_b16 a[76:77], v67 offset:24576
  ds_read_b64_tr_b16 a[78:79], v67 offset:26624
  ds_read_b64_tr_b16 a[100:101], v70 offset:24576
  ds_read_b64_tr_b16 a[102:103], v70 offset:26624
  ds_read_b64_tr_b16 a[108:109], v71 offset:24576
  ds_read_b64_tr_b16 a[110:111], v71 offset:26624
  s_waitcnt vmcnt(8)
  s_waitcnt lgkmcnt(0)
  s_barrier
  ds_read_b64_tr_b16 a[80:81], v68 offset:0
  ds_read_b64_tr_b16 a[82:83], v68 offset:2048
  ds_read_b64_tr_b16 a[88:89], v69 offset:0
  ds_read_b64_tr_b16 a[90:91], v69 offset:2048
  ds_read_b64_tr_b16 a[112:113], v72 offset:0
  ds_read_b64_tr_b16 a[114:115], v72 offset:2048
  ds_read_b64_tr_b16 a[120:121], v73 offset:0
  ds_read_b64_tr_b16 a[122:123], v73 offset:2048
  s_waitcnt vmcnt(4)
  s_waitcnt lgkmcnt(0)
  s_barrier
  s_add_u32 m0, s53, 0
  s_add_u32 s38, s49, 0
  buffer_load_dwordx4 v33, s[28:31], s38 offen  lds
  s_add_u32 m0, s53, 1024
  s_add_u32 s38, s49, 2048
  buffer_load_dwordx4 v33, s[28:31], s38 offen  lds
  s_add_u32 m0, s53, 2048
  s_add_u32 s38, s49, 8192
  buffer_load_dwordx4 v33, s[28:31], s38 offen  lds
  s_add_u32 m0, s53, 3072
  s_add_u32 s38, s49, 10240
  buffer_load_dwordx4 v33, s[28:31], s38 offen  lds
  ds_read_b64_tr_b16 a[84:85], v68 offset:4096
  ds_read_b64_tr_b16 a[86:87], v68 offset:6144
  ds_read_b64_tr_b16 a[92:93], v69 offset:4096
  ds_read_b64_tr_b16 a[94:95], v69 offset:6144
  ds_read_b64_tr_b16 a[116:117], v72 offset:4096
  ds_read_b64_tr_b16 a[118:119], v72 offset:6144
  ds_read_b64_tr_b16 a[124:125], v73 offset:4096
  ds_read_b64_tr_b16 a[126:127], v73 offset:6144
c_wreg:
  v_readfirstlane_b32 s36, v58
  v_readfirstlane_b32 s2, v59
  v_readfirstlane_b32 s37, v60
  s_cmp_eq_u32 s36, -1
  s_cselect_b32 s36, s37, 0
  s_cmp_ge_u32 s36, 64
  s_cbranch_scc1 c_wreg_ok
  s_sleep 4
  buffer_load_dwordx2 v[58:59], v56, s[12:15], 0 offen sc1
  buffer_load_dword v60, v56, s[12:15], 0 offen offset:64 sc1
  s_waitcnt vmcnt(0)
  s_sub_u32 s35, s35, 1
  s_cbranch_scc0 c_wreg
  s_mov_b32 s35, 0
c_wreg_ok:
  s_cmp_lg_u32 s2, 0
  s_cbranch_scc1 c_initx
  buffer_store_dwordx4 v[28:31], v0, s[8:11], s65 offen
  buffer_store_dwordx4 v[28:31], v0, s[8:11], s65 offen offset:1024
  s_add_u32 s64, s65, 0x40000
  buffer_store_dwordx4 v[28:31], v0, s[8:11], s64 offen
  buffer_store_dwordx4 v[28:31], v0, s[8:11], s64 offen offset:1024
  s_cmp_ge_u32 s32, 2
  s_cbranch_scc1 c_inited
  s_mov_b32 s38, 458752
  s_mov_b64 exec, 0xffffff00
  buffer_store_dwordx4 v[28:31], v21, s[8:11], s38 offen
  s_mov_b64 exec, s[80:81]
  buffer_store_dword v15, v4, s[8:11], s38 offen
  s_mov_b64 exec, -1
  s_branch c_inited
c_initx:
  buffer_store_dwordx4 v[28:31], v0, s[8:11], s65 offen sc1
  buffer_store_dwordx4 v[28:31], v0, s[8:11], s65 offen offset:1024 sc1
  s_add_u32 s64, s65, 0x40000
  buffer_store_dwordx4 v[28:31], v0, s[8:11], s64 offen sc1
  buffer_store_dwordx4 v[28:31], v0, s[8:11], s64 offen offset:1024 sc1
  s_cmp_ge_u32 s32, 2
  s_cbranch_scc1 c_inited
  s_mov_b32 s38, 458752
  s_mov_b64 exec, 0xffffff00
  buffer_store_dwordx4 v[28:31], v21, s[8:11], s38 offen sc1
  s_mov_b64 exec, s[80:81]
  buffer_store_dword v15, v4, s[8:11], s38 offen sc1
  s_mov_b64 exec, -1
c_inited:
  s_add_u32 s64, s65, 0x80000
  v_lshrrev_b32 v56, 2, v0
  s_lshl_b32 s88, s33, 8
  buffer_load_dword v57, v56, s[8:11], s88 offen sc1
  s_waitcnt vmcnt(4)
  s_waitcnt lgkmcnt(0)
  s_barrier
  s_add_u32 m0, s53, 4096
  s_add_u32 s38, s50, 0
  buffer_load_dwordx4 v33, s[28:31], s38 offen  lds
  s_add_u32 m0, s53, 5120
  s_add_u32 s38, s50, 2048
  buffer_load_dwordx4 v33, s[28:31], s38 offen  lds
  s_add_u32 m0, s53, 6144
  s_add_u32 s38, s50, 8192
  buffer_load_dwordx4 v33, s[28:31], s38 offen  lds
  s_add_u32 m0, s53, 7168
  s_add_u32 s38, s50, 10240
  buffer_load_dwordx4 v33, s[28:31], s38 offen  lds
  ds_read_b64_tr_b16 v[176:177], v35 offset:8192
  ds_read_b64_tr_b16 v[178:179], v35 offset:9216
  ds_read_b64_tr_b16 v[180:181], v35 offset:10240
  ds_read_b64_tr_b16 v[182:183], v35 offset:11264
  ds_read_b64_tr_b16 v[184:185], v35 offset:8704
  ds_read_b64_tr_b16 v[186:187], v35 offset:9728
  ds_read_b64_tr_b16 v[188:189], v35 offset:10752
  ds_read_b64_tr_b16 v[190:191], v35 offset:11776
  s_waitcnt vmcnt(4)
  ds_read_b64_tr_b16 v[208:209], v35 offset:0
  ds_read_b64_tr_b16 v[210:211], v35 offset:1024
  ds_read_b64_tr_b16 v[212:213], v35 offset:2048
  ds_read_b64_tr_b16 v[214:215], v35 offset:3072
  ds_read_b64_tr_b16 v[216:217], v35 offset:512
  ds_read_b64_tr_b16 v[218:219], v35 offset:1536
  ds_read_b64_tr_b16 v[220:221], v35 offset:2560
  ds_read_b64_tr_b16 v[222:223], v35 offset:3584
  s_waitcnt lgkmcnt(8)
  s_add_u32 m0, s53, 8192
  s_add_u32 s38, s51, 0
  buffer_load_dwordx4 v33, s[28:31], s38 offen  lds
  s_add_u32 m0, s53, 9216
  s_add_u32 s38, s51, 2048
  buffer_load_dwordx4 v33, s[28:31], s38 offen  lds
  s_add_u32 m0, s53, 10240
  s_add_u32 s38, s51, 8192
  buffer_load_dwordx4 v33, s[28:31], s38 offen  lds
  s_add_u32 m0, s53, 11264
  s_add_u32 s38, s51, 10240
  buffer_load_dwordx4 v33, s[28:31], s38 offen  lds
  s_waitcnt vmcnt(4)
  ds_read_b64_tr_b16 v[224:225], v35 offset:4096
  ds_read_b64_tr_b16 v[226:227], v35 offset:5120
  ds_read_b64_tr_b16 v[228:229], v35 offset:6144
  ds_read_b64_tr_b16 v[230:231], v35 offset:7168
  ds_read_b64_tr_b16 v[232:233], v35 offset:4608
  ds_read_b64_tr_b16 v[234:235], v35 offset:5632
  ds_read_b64_tr_b16 v[236:237], v35 offset:6656
  ds_read_b64_tr_b16 v[238:239], v35 offset:7680
  s_waitcnt lgkmcnt(8)
  s_add_u32 m0, s53, 0
  s_add_u32 s38, s48, 128
  buffer_load_dwordx4 v33, s[28:31], s38 offen  lds
  s_add_u32 m0, s53, 1024
  s_add_u32 s38, s48, 2176
  buffer_load_dwordx4 v33, s[28:31], s38 offen  lds
  s_add_u32 m0, s53, 2048
  s_add_u32 s38, s48, 8320
  buffer_load_dwordx4 v33, s[28:31], s38 offen  lds
  s_add_u32 m0, s53, 3072
  s_add_u32 s38, s48, 10368
  buffer_load_dwordx4 v33, s[28:31], s38 offen  lds
  s_add_u32 m0, s52, 16384
  s_add_u32 s38, s49, 128
  buffer_load_dwordx4 v33, s[28:31], s38 offen  lds
  s_add_u32 m0, s52, 17408
  s_add_u32 s38, s49, 2176
  buffer_load_dwordx4 v33, s[28:31], s38 offen  lds
  s_add_u32 m0, s52, 18432
  s_add_u32 s38, s49, 8320
  buffer_load_dwordx4 v33, s[28:31], s38 offen  lds
  s_add_u32 m0, s52, 19456
  s_add_u32 s38, s49, 10368
  buffer_load_dwordx4 v33, s[28:31], s38 offen  lds
  s_add_u32 m0, s52, 20480
  s_add_u32 s38, s50, 128
  buffer_load_dwordx4 v33, s[28:31], s38 offen  lds
  s_add_u32 m0, s52, 21504
  s_add_u32 s38, s50, 2176
  buffer_load_dwordx4 v33, s[28:31], s38 offen  lds
  s_add_u32 m0, s52, 22528
  s_add_u32 s38, s50, 8320
  buffer_load_dwordx4 v33, s[28:31], s38 offen  lds
  s_add_u32 m0, s52, 23552
  s_add_u32 s38, s50, 10368
  buffer_load_dwordx4 v33, s[28:31], s38 offen  lds
  s_add_u32 m0, s52, 24576
  s_add_u32 s38, s51, 128
  buffer_load_dwordx4 v33, s[28:31], s38 offen  lds
  s_add_u32 m0, s52, 25600
  s_add_u32 s38, s51, 2176
  buffer_load_dwordx4 v33, s[28:31], s38 offen  lds
  s_add_u32 m0, s52, 26624
  s_add_u32 s38, s51, 8320
  buffer_load_dwordx4 v33, s[28:31], s38 offen  lds
  s_add_u32 m0, s52, 27648
  s_add_u32 s38, s51, 10368
  buffer_load_dwordx4 v33, s[28:31], s38 offen  lds
  s_waitcnt vmcnt(16)
  ds_read_b64_tr_b16 v[240:241], v35 offset:8192
  ds_read_b64_tr_b16 v[242:243], v35 offset:9216
  ds_read_b64_tr_b16 v[244:245], v35 offset:10240
  ds_read_b64_tr_b16 v[246:247], v35 offset:11264
  ds_read_b64_tr_b16 v[248:249], v35 offset:8704
  ds_read_b64_tr_b16 v[250:251], v35 offset:9728
  ds_read_b64_tr_b16 v[252:253], v35 offset:10752
  ds_read_b64_tr_b16 v[254:255], v35 offset:11776
  s_getpc_b64 s[6:7]
c_pc:
  s_add_u32 s6, s6, c0_top-c_pc
  s_addc_u32 s7, s7, 0
  v_lshlrev_b32 v60, 2, v0
  global_load_dword v61, v60, s[6:7]
  s_waitcnt vmcnt(12)
  ds_read_b64_tr_b16 v[192:193], v35 offset:0
  ds_read_b64_tr_b16 v[194:195], v35 offset:1024
  ds_read_b64_tr_b16 v[196:197], v35 offset:2048
  ds_read_b64_tr_b16 v[198:199], v35 offset:3072
  ds_read_b64_tr_b16 v[200:201], v35 offset:512
  ds_read_b64_tr_b16 v[202:203], v35 offset:1536
  ds_read_b64_tr_b16 v[204:205], v35 offset:2560
  ds_read_b64_tr_b16 v[206:207], v35 offset:3584
  s_waitcnt vmcnt(8)
  ds_read_b64_tr_b16 v[40:41], v34 offset:16384
  ds_read_b64_tr_b16 v[42:43], v34 offset:17408
  ds_read_b64_tr_b16 v[44:45], v34 offset:18432
  ds_read_b64_tr_b16 v[46:47], v34 offset:19456
  ds_read_b64_tr_b16 v[48:49], v34 offset:16896
  ds_read_b64_tr_b16 v[50:51], v34 offset:17920
  ds_read_b64_tr_b16 v[52:53], v34 offset:18944
  ds_read_b64_tr_b16 v[54:55], v34 offset:19968
  v_cmp_le_u32 s[70:71], 4, v57
  v_lshlrev_b32 v62, 2, v0
  s_nop 0
  s_and_b32 s36, s70, 3
  s_cmp_lg_u32 s36, 3
  s_cbranch_scc1 c_nopf
  s_add_u32 s36, s57, 16384
  buffer_load_dword v63, v62, s[8:11], s57 offen sc1
  buffer_load_dword v63, v62, s[8:11], s36 offen sc1
c_nopf:
  s_waitcnt lgkmcnt(0)
  ds_write_b128 v11, v[40:43] offset:16384
  ds_write_b128 v11, v[44:47] offset:17408
  ds_write_b128 v11, v[48:51] offset:18432
  ds_write_b128 v11, v[52:55] offset:19456
  s_waitcnt lgkmcnt(0)
  s_waitcnt vmcnt(4)
  ds_read_b64_tr_b16 v[40:41], v34 offset:20480
  ds_read_b64_tr_b16 v[42:43], v34 offset:21504
  ds_read_b64_tr_b16 v[44:45], v34 offset:22528
  ds_read_b64_tr_b16 v[46:47], v34 offset:23552
  ds_read_b64_tr_b16 v[48:49], v34 offset:20992
  ds_read_b64_tr_b16 v[50:51], v34 offset:22016
  ds_read_b64_tr_b16 v[52:53], v34 offset:23040
  ds_read_b64_tr_b16 v[54:55], v34 offset:24064
  buffer_load_dword v57, v56, s[8:11], s88 offen sc1
  s_waitcnt lgkmcnt(0)
  ds_write_b128 v11, v[40:43] offset:20480
  ds_write_b128 v11, v[44:47] offset:21504
  ds_write_b128 v11, v[48:51] offset:22528
  ds_write_b128 v11, v[52:55] offset:23552
  s_waitcnt lgkmcnt(0)
  s_waitcnt vmcnt(0)
  ds_read_b64_tr_b16 v[40:41], v34 offset:24576
  ds_read_b64_tr_b16 v[42:43], v34 offset:25600
  ds_read_b64_tr_b16 v[44:45], v34 offset:26624
  ds_read_b64_tr_b16 v[46:47], v34 offset:27648
  ds_read_b64_tr_b16 v[48:49], v34 offset:25088
  ds_read_b64_tr_b16 v[50:51], v34 offset:26112
  ds_read_b64_tr_b16 v[52:53], v34 offset:27136
  ds_read_b64_tr_b16 v[54:55], v34 offset:28160
  v_lshlrev_b32 v64, 1, v0
  s_add_u32 s37, s65, 0
  buffer_load_dword v65, v64, s[8:11], s37 offen sc1
  s_add_u32 s37, s65, 262144
  buffer_load_dword v65, v64, s[8:11], s37 offen sc1
  s_add_u32 s37, s65, 524288
  buffer_load_dword v65, v64, s[8:11], s37 offen sc1
  s_add_u32 s37, s65, 786432
  buffer_load_dword v65, v64, s[8:11], s37 offen sc1
  s_mov_b32 s37, 458752
  buffer_load_dword v65, v21, s[8:11], s37 offen sc1
  s_waitcnt lgkmcnt(0)
  ds_write_b128 v11, v[40:43] offset:24576
  ds_write_b128 v11, v[44:47] offset:25600
  ds_write_b128 v11, v[48:51] offset:26624
  ds_write_b128 v11, v[52:55] offset:27648
  s_waitcnt lgkmcnt(0)
  s_waitcnt lgkmcnt(0)
  s_barrier
  s_waitcnt vmcnt(0)
  s_lshl_b32 s36, s33, 4
  s_lshl_b32 s37, s32, 2
  s_add_u32 s36, s36, s37
  s_add_u32 s36, s36, 12288
  s_mov_b64 exec, 1
  s_cmp_lg_u32 s2, 0
  s_cbranch_scc1 c_rbx
  buffer_store_dword v28, off, s[8:11], s36
  s_branch c_rb
c_rbx:
  buffer_store_dword v28, off, s[8:11], s36 sc1
c_rb:
  s_mov_b64 exec, -1
  v_cmp_le_u32 s[70:71], 4, v57
  s_mov_b32 s86, 0x3f803f80
  s_mov_b32 s87, 0x3f803f80
  s_mov_b32 s34, 0
  s_mov_b32 s69, 0
  s_mov_b32 s36, 0
  s_bitcmp1_b64 s[70:71], s36
  s_cbranch_scc0 c_kv0_slow
c_kv0_ok:
  s_mov_b32 s36, 1
  s_bitcmp1_b64 s[70:71], s36
  s_cbranch_scc0 c_kv1_slow
c_kv1_ok:
  s_mov_b32 m0, s66
  s_nop 0
  buffer_load_dwordx4 v0, s[8:11], s57 offen offset:0 sc1 lds
  buffer_load_dwordx4 v0, s[8:11], s57 offen offset:1024 sc1 lds
  buffer_load_dwordx4 v0, s[8:11], s57 offen offset:2048 sc1 lds
  buffer_load_dwordx4 v0, s[8:11], s57 offen offset:3072 sc1 lds
  s_add_u32 s57, s57, 16384
  ds_read_b128 v[72:75], v11 offset:6144
  ds_read_b128 v[76:79], v11 offset:7168
  ds_read_b128 v[80:83], v11 offset:8192
  ds_read_b128 v[84:87], v11 offset:9216
  ds_read_b128 v[88:91], v11 offset:10240
  ds_read_b128 v[92:95], v11 offset:11264
  ds_read_b128 v[96:99], v11 offset:12288
  ds_read_b128 v[100:103], v11 offset:13312
  ds_read_b128 v[104:107], v11 offset:14336
  ds_read_b128 v[108:111], v11 offset:15360
  ds_read_b128 v[24:27], v11 offset:0
  ds_read_b128 v[28:31], v11 offset:1024
  ds_read_b128 v[32:35], v11 offset:2048
  ds_read_b128 v[36:39], v11 offset:3072
  v_mov_b64 v[56:57], 0
  v_mov_b64 v[58:59], 0
  v_mov_b64 v[60:61], 0
  v_mov_b64 v[62:63], 0
  v_mov_b64 v[64:65], 0
  v_mov_b64 v[66:67], 0
  v_mov_b64 v[68:69], 0
  v_mov_b64 v[70:71], 0
  s_waitcnt lgkmcnt(0)
  v_lshrrev_b32 v12, 1, v0
  s_mov_b32 s37, 12288
c_wb:
  buffer_load_dwordx2 v[16:17], v12, s[8:11], s37 offen sc1
  s_waitcnt vmcnt(0)
  v_and_b32 v16, v16, v17
  v_cmp_ne_u32 vcc, -1, v16
  s_cbranch_vccz c_wb_ok
  s_sleep 2
  s_sub_u32 s35, s35, 1
  s_cbranch_scc0 c_wb
  s_mov_b32 s35, 0
c_wb_ok:
  s_cmp_lg_u32 s2, 0
  s_cbranch_scc1 cx0_top
  s_branch c0_top
.p2align 8
.fill 2, 4, 0xbf800000
c0_top:
  s_sub_u32 m0, s67, s69
  s_mov_b32 s3, 0
  buffer_load_dwordx4 v[16:19], v0, s[8:11], s54 offen offset:0 sc1
  buffer_load_dwordx4 v[20:23], v0, s[8:11], s54 offen offset:1024 sc1
  ds_read_b128 v[40:43], v11 offset:4096
  ds_read_b128 v[44:47], v11 offset:5120
  s_sleep 3
  buffer_load_dwordx4 v[16:19], v0, s[8:11], s54 offen offset:0 sc1
  buffer_load_dwordx4 v[20:23], v0, s[8:11], s54 offen offset:1024 sc1
  s_waitcnt lgkmcnt(0)
c0_chkA:
  s_waitcnt vmcnt(3)
  v_smfmac_f32_16x16x64_bf16 v[64:67], v[16:19], v[24:31], v1
  ds_write_b128 v7, v[16:19] offset:0
  s_waitcnt vmcnt(2)
  v_mov_b64 v[48:49], 0
  v_smfmac_f32_16x16x64_bf16 v[64:67], v[20:23], v[40:47], v1
  ds_write_b128 v7, v[20:23] offset:1024
  v_smfmac_f32_16x16x64_bf16 v[68:71], v[16:19], v[32:39], v1
  v_mov_b64 v[50:51], 0
  v_smfmac_f32_16x16x64_bf16 v[68:71], v[20:23], v[72:79], v1
  v_mov_b64 v[52:53], 0
  v_smfmac_f32_16x16x64_bf16 v[56:59], v[16:19], v[80:87], v1
  s_nop 1
  v_cmp_u_f32 vcc, v64, v65
  v_cmp_u_f32 s[6:7], v66, v67
  v_smfmac_f32_16x16x64_bf16 v[60:63], v[16:19], v[88:95], v1
  s_or_b64 vcc, vcc, s[6:7]
  s_cbranch_scc1 c0_reA
c0_okA:
  v_smfmac_f32_16x16x64_bf16 v[56:59], v[20:23], v[96:103], v1
  v_mov_b64 v[54:55], 0
  v_smfmac_f32_16x16x64_bf16 v[60:63], v[20:23], v[104:111], v1
  s_waitcnt vmcnt(0)
  s_waitcnt lgkmcnt(0)
  s_barrier
  v_smfmac_f32_16x16x64_bf16 v[48:51], v[16:19], a[0:7], v1
  ds_read_b128 v[24:27], v8 offset:0
  buffer_load_dwordx4 v0, s[8:11], s57 offen offset:0 sc1 lds
  v_add_u32 v12, s69, v0
  v_smfmac_f32_16x16x64_bf16 v[52:55], v[16:19], a[8:15], v1
  ds_read_b128 v[28:31], v9 offset:0
  v_smfmac_f32_16x16x64_bf16 v[48:51], v[20:23], a[16:23], v1
  ds_read_b128 v[32:35], v10 offset:0
  v_smfmac_f32_16x16x64_bf16 v[52:55], v[20:23], a[24:31], v1
  ds_read_b128 v[36:39], v8 offset:1024
  s_waitcnt lgkmcnt(3)
  v_smfmac_f32_16x16x64_bf16 v[48:51], v[24:27], a[32:39], v1
  ds_read_b128 v[40:43], v9 offset:1024
  buffer_load_dwordx4 v0, s[8:11], s57 offen offset:1024 sc1 lds
  v_smfmac_f32_16x16x64_bf16 v[52:55], v[24:27], a[40:47], v1
  ds_read_b128 v[44:47], v10 offset:1024
  s_waitcnt lgkmcnt(4)
  v_smfmac_f32_16x16x64_bf16 v[48:51], v[28:31], a[64:71], v1
  ds_read_b128 v[72:75], v12 offset:16384
  v_smfmac_f32_16x16x64_bf16 v[52:55], v[28:31], a[72:79], v1
  ds_read_b128 v[76:79], v12 offset:20480
  s_waitcnt lgkmcnt(5)
  v_smfmac_f32_16x16x64_bf16 v[48:51], v[32:35], a[96:103], v1
  ds_read_b128 v[80:83], v12 offset:17408
  buffer_load_dwordx4 v0, s[8:11], s57 offen offset:2048 sc1 lds
  v_mov_b64 v[16:17], -1
  v_smfmac_f32_16x16x64_bf16 v[52:55], v[32:35], a[104:111], v1
  ds_read_b128 v[84:87], v12 offset:21504
  s_waitcnt lgkmcnt(6)
  v_mov_b64 v[18:19], -1
  v_smfmac_f32_16x16x64_bf16 v[48:51], v[36:39], a[48:55], v1
  ds_read_b128 v[88:91], v12 offset:18432
  v_smfmac_f32_16x16x64_bf16 v[52:55], v[36:39], a[56:63], v1
  ds_read_b128 v[92:95], v12 offset:22528
  s_waitcnt lgkmcnt(7)
  v_smfmac_f32_16x16x64_bf16 v[48:51], v[40:43], a[80:87], v1
  ds_read_b128 v[96:99], v12 offset:19456
  buffer_load_dwordx4 v0, s[8:11], s57 offen offset:3072 sc1 lds
  v_smfmac_f32_16x16x64_bf16 v[52:55], v[40:43], a[88:95], v1
  ds_read_b128 v[100:103], v12 offset:23552
  s_waitcnt lgkmcnt(8)
  v_lshrrev_b32 v13, 2, v0
  v_smfmac_f32_16x16x64_bf16 v[48:51], v[44:47], a[112:119], v1
  buffer_load_dword v14, v13, s[8:11], s88 offen sc1
  buffer_store_dwordx4 v[16:19], v0, s[8:11], s64 offen
  v_add_u32 v13, s69, v7
  v_smfmac_f32_16x16x64_bf16 v[52:55], v[44:47], a[120:127], v1
  v_smfmac_f32_16x16x64_bf16 v[56:59], v[24:27], a[128:135], v1
  ds_read_b128 v[104:107], v13 offset:24576
  v_smfmac_f32_16x16x64_bf16 v[60:63], v[24:27], a[136:143], v1
  buffer_store_dword v15, v4, s[8:11], s56 offen sc1
  v_smfmac_f32_16x16x64_bf16 v[56:59], v[28:31], a[160:167], v1
  ds_read_b128 v[108:111], v13 offset:25600
  s_nop 1
  v_permlane32_swap_b32 v48, v52
  v_smfmac_f32_16x16x64_bf16 v[60:63], v[28:31], a[168:175], v1
  v_permlane32_swap_b32 v49, v53
  v_smfmac_f32_16x16x64_bf16 v[56:59], v[32:35], a[192:199], v1
  v_permlane32_swap_b32 v50, v54
  v_smfmac_f32_16x16x64_bf16 v[60:63], v[32:35], a[200:207], v1
  buffer_store_dwordx4 v[16:19], v0, s[8:11], s64 offen offset:1024
  v_permlane32_swap_b32 v51, v55
  v_smfmac_f32_16x16x64_bf16 v[56:59], v[36:39], a[144:151], v1
  v_add_f32 v48, v48, v52
  v_smfmac_f32_16x16x64_bf16 v[60:63], v[36:39], a[152:159], v1
  v_add_f32 v49, v49, v53
  v_smfmac_f32_16x16x64_bf16 v[56:59], v[40:43], a[176:183], v1
  v_add_f32 v50, v50, v54
  v_add_f32 v51, v51, v55
  v_smfmac_f32_16x16x64_bf16 v[60:63], v[40:43], a[184:191], v1
  v_mul_f32 v48, s68, v48
  v_smfmac_f32_16x16x64_bf16 v[56:59], v[44:47], a[208:215], v1
  v_mul_f32 v49, s68, v49
  v_mul_f32 v50, s68, v50
  v_smfmac_f32_16x16x64_bf16 v[60:63], v[44:47], a[216:223], v1
  v_mul_f32 v51, s68, v51
  v_smfmac_f32_16x16x64_bf16 v[64:67], v[24:27], a[224:231], v1
  v_cvt_pk_bf16_f32 v12, v48, v49
  v_cvt_pk_bf16_f32 v13, v50, v51
  v_smfmac_f32_16x16x64_bf16 v[68:71], v[24:27], a[232:239], v1
  ds_write_b64 v5, v[12:13] offset:9216
  v_smfmac_f32_16x16x64_bf16 v[64:67], v[28:31], v[112:119], v1
  s_nop 0
  v_permlane32_swap_b32 v56, v60
  v_permlane32_swap_b32 v57, v61
  v_smfmac_f32_16x16x64_bf16 v[68:71], v[28:31], v[120:127], v1
  v_permlane32_swap_b32 v58, v62
  v_permlane32_swap_b32 v59, v63
  v_smfmac_f32_16x16x64_bf16 v[64:67], v[32:35], v[144:151], v1
  v_add_f32 v56, v56, v60
  v_smfmac_f32_16x16x64_bf16 v[68:71], v[32:35], v[152:159], v1
  s_waitcnt lgkmcnt(0)
  s_barrier
  v_add_f32 v57, v57, v61
  v_add_f32 v58, v58, v62
  v_smfmac_f32_16x16x64_bf16 v[64:67], v[36:39], a[240:247], v1
  ds_read_b64_tr_b16 v[48:49], v6 offset:9216
  ds_read_b64_tr_b16 v[50:51], v6 offset:9472
  v_add_f32 v59, v59, v63
  v_cvt_pk_bf16_f32 v12, v56, v57
  v_smfmac_f32_16x16x64_bf16 v[68:71], v[36:39], a[248:255], v1
  ds_read_b64_tr_b16 v[52:53], v6 offset:11264
  ds_read_b64_tr_b16 v[54:55], v6 offset:11520
  v_cvt_pk_bf16_f32 v13, v58, v59
  v_smfmac_f32_16x16x64_bf16 v[64:67], v[40:43], v[128:135], v1
  ds_write_b64 v5, v[12:13] offset:9728
  v_smfmac_f32_16x16x64_bf16 v[68:71], v[40:43], v[136:143], v1
  ds_read_b64_tr_b16 v[16:17], v6 offset:13312
  ds_read_b64_tr_b16 v[18:19], v6 offset:13568
  v_smfmac_f32_16x16x64_bf16 v[64:67], v[44:47], v[160:167], v1
  ds_read_b64_tr_b16 v[20:21], v6 offset:15360
  ds_read_b64_tr_b16 v[22:23], v6 offset:15616
  v_smfmac_f32_16x16x64_bf16 v[68:71], v[44:47], v[168:175], v1
  s_waitcnt lgkmcnt(7)
  v_mfma_f32_16x16x32_bf16 v[56:59], v[72:75], v[48:51], 0
  v_mfma_f32_16x16x32_bf16 v[60:63], v[76:79], v[48:51], 0
  s_waitcnt lgkmcnt(5)
  s_waitcnt lgkmcnt(4)
  s_barrier
  v_mfma_f32_16x16x32_bf16 v[56:59], v[80:83], v[52:55], v[56:59]
  ds_read_b64_tr_b16 v[24:25], v6 offset:9728
  ds_read_b64_tr_b16 v[26:27], v6 offset:9984
  v_cvt_pk_bf16_f32 v44, v64, v65
  v_mfma_f32_16x16x32_bf16 v[60:63], v[84:87], v[52:55], v[60:63]
  ds_read_b64_tr_b16 v[28:29], v6 offset:11776
  ds_read_b64_tr_b16 v[30:31], v6 offset:12032
  v_cvt_pk_bf16_f32 v45, v66, v67
  s_waitcnt lgkmcnt(6)
  v_mfma_f32_16x16x32_bf16 v[56:59], v[88:91], v[16:19], v[56:59]
  ds_read_b64_tr_b16 v[32:33], v6 offset:13824
  ds_read_b64_tr_b16 v[34:35], v6 offset:14080
  v_mfma_f32_16x16x32_bf16 v[60:63], v[92:95], v[16:19], v[60:63]
  ds_read_b64_tr_b16 v[36:37], v6 offset:15872
  ds_read_b64_tr_b16 v[38:39], v6 offset:16128
  s_waitcnt lgkmcnt(8)
  v_mfma_f32_16x16x32_bf16 v[56:59], v[96:99], v[20:23], v[56:59]
  ds_read_b128 v[72:75], v11 offset:16384
  v_cvt_pk_bf16_f32 v46, v68, v69
  v_mfma_f32_16x16x32_bf16 v[60:63], v[100:103], v[20:23], v[60:63]
  ds_read_b128 v[76:79], v11 offset:17408
  v_cvt_pk_bf16_f32 v47, v70, v71
  s_waitcnt lgkmcnt(8)
  v_mfma_f32_16x16x32_bf16 v[40:43], v[24:27], v[48:51], 0
  ds_read_b128 v[80:83], v11 offset:18432
  v_mov_b64 v[24:25], s[86:87]
  s_waitcnt lgkmcnt(7)
  v_mfma_f32_16x16x32_bf16 v[40:43], v[28:31], v[52:55], v[40:43]
  ds_read_b128 v[84:87], v11 offset:19456
  v_max3_f32 v12, v56, v57, v58
  s_waitcnt lgkmcnt(6)
  v_mfma_f32_16x16x32_bf16 v[40:43], v[32:35], v[16:19], v[40:43]
  ds_read_b128 v[88:91], v11 offset:20480
  v_max3_f32 v13, v59, v60, v61
  s_waitcnt lgkmcnt(5)
  v_mfma_f32_16x16x32_bf16 v[40:43], v[36:39], v[20:23], v[40:43]
  ds_read_b128 v[92:95], v11 offset:21504
  v_max3_f32 v12, v12, v62, v63
  v_max_f32 v12, v12, v13
  v_mov_b32 v13, v12
  v_mov_b64 v[26:27], s[86:87]
  v_cndmask_b32 v28, 0, v24, s[82:83]
  v_permlane32_swap_b32 v12, v13
  v_cndmask_b32 v29, 0, v24, s[82:83]
  v_max3_f32 v12, v12, v13, v40
  v_max3_f32 v13, v41, v42, v43
  v_max_f32 v12, v12, v13
  v_mov_b32 v13, v12
  v_mov_b64 v[48:49], 0
  v_mov_b64 v[50:51], 0
  v_permlane16_swap_b32 v12, v13
  v_max_f32 v12, v12, v13
  v_sub_f32 v56, v56, v12
  v_sub_f32 v57, v57, v12
  v_sub_f32 v58, v58, v12
  v_sub_f32 v59, v59, v12
  v_sub_f32 v60, v60, v12
  v_sub_f32 v61, v61, v12
  v_sub_f32 v62, v62, v12
  v_sub_f32 v63, v63, v12
  v_exp_f32 v56, v56
  v_exp_f32 v57, v57
  v_exp_f32 v58, v58
  v_exp_f32 v59, v59
  v_exp_f32 v60, v60
  v_exp_f32 v61, v61
  v_exp_f32 v62, v62
  v_exp_f32 v63, v63
  v_cvt_pk_bf16_f32 v32, v56, v57
  v_cvt_pk_bf16_f32 v33, v58, v59
  v_cvt_pk_bf16_f32 v34, v60, v61
  v_cvt_pk_bf16_f32 v35, v62, v63
  v_sub_f32 v40, v40, v12
  v_sub_f32 v41, v41, v12
  v_mfma_f32_16x16x32_bf16 v[36:39], v[24:27], v[32:35], 0
  ds_read_b128 v[96:99], v11 offset:22528
  v_sub_f32 v42, v42, v12
  v_sub_f32 v43, v43, v12
  v_mfma_f32_16x16x32_bf16 v[64:67], v[104:107], v[32:35], 0
  ds_read_b128 v[100:103], v11 offset:23552
  v_exp_f32 v40, v40
  v_mfma_f32_16x16x32_bf16 v[68:71], v[108:111], v[32:35], 0
  v_exp_f32 v41, v41
  v_exp_f32 v42, v42
  v_exp_f32 v43, v43
  v_cvt_pk_bf16_f32 v30, v40, v41
  v_cvt_pk_bf16_f32 v31, v42, v43
  v_mov_b64 v[52:53], 0
  v_mov_b64 v[54:55], 0
  v_mfma_f32_16x16x16_bf16 v[36:39], v[28:29], v[30:31], v[36:39]
  v_mov_b64 v[16:17], 0
  v_mov_b64 v[18:19], 0
  v_mfma_f32_16x16x16_bf16 v[64:67], v[44:45], v[30:31], v[64:67]
  v_mov_b64 v[20:21], 0
  v_mov_b64 v[22:23], 0
  v_mfma_f32_16x16x16_bf16 v[68:71], v[46:47], v[30:31], v[68:71]
  s_nop 1
  v_rcp_f32 v12, v36
  s_nop 1
  v_mul_f32 v64, v64, v12
  v_mul_f32 v65, v65, v12
  v_mul_f32 v66, v66, v12
  v_mul_f32 v67, v67, v12
  v_cvt_pk_bf16_f32 v56, v64, v65
  v_cvt_pk_bf16_f32 v57, v66, v67
  v_mul_f32 v68, v68, v12
  v_mul_f32 v69, v69, v12
  v_mul_f32 v70, v70, v12
  v_mul_f32 v71, v71, v12
  v_cvt_pk_bf16_f32 v58, v68, v69
  v_cvt_pk_bf16_f32 v59, v70, v71
  ds_write_b128 v7, v[56:59] offset:8192
  s_nop 0
  v_smfmac_f32_16x16x64_bf16 v[48:51], v[56:59], v[176:183], v1
  v_cndmask_b32 v44, 0, v3, s[72:73]
  v_smfmac_f32_16x16x64_bf16 v[52:55], v[56:59], v[184:191], v1
  v_cndmask_b32 v45, 0, v3, s[74:75]
  v_smfmac_f32_16x16x64_bf16 v[16:19], v[56:59], v[192:199], v1
  v_cndmask_b32 v46, 0, v3, s[72:73]
  v_smfmac_f32_16x16x64_bf16 v[20:23], v[56:59], v[200:207], v1
  v_cndmask_b32 v47, 0, v3, s[74:75]
  s_waitcnt lgkmcnt(0)
  s_barrier
  ds_read_b128 v[60:63], v8 offset:8192
  ds_read_b128 v[40:43], v9 offset:8192
  ds_read_b128 v[32:35], v10 offset:8192
  s_waitcnt lgkmcnt(2)
  v_smfmac_f32_16x16x64_bf16 v[48:51], v[60:63], v[208:215], v1
  ds_read_b128 v[104:107], v11 offset:24576
  v_smfmac_f32_16x16x64_bf16 v[52:55], v[60:63], v[216:223], v1
  ds_read_b128 v[108:111], v11 offset:25600
  s_waitcnt lgkmcnt(3)
  v_smfmac_f32_16x16x64_bf16 v[48:51], v[40:43], v[224:231], v1
  ds_read_b128 v[24:27], v11 offset:26624
  v_smfmac_f32_16x16x64_bf16 v[52:55], v[40:43], v[232:239], v1
  ds_read_b128 v[28:31], v11 offset:27648
  s_waitcnt lgkmcnt(4)
  v_smfmac_f32_16x16x64_bf16 v[48:51], v[32:35], v[240:247], v1
  v_smfmac_f32_16x16x64_bf16 v[52:55], v[32:35], v[248:255], v1
  v_smfmac_f32_16x16x64_bf16 v[16:19], v[60:63], v[72:79], v1
  v_smfmac_f32_16x16x64_bf16 v[20:23], v[60:63], v[80:87], v1
  v_smfmac_f32_16x16x64_bf16 v[16:19], v[40:43], v[88:95], v1
  s_nop 4
  v_cvt_pk_bf16_f32 v64, v48, v52
  v_cvt_pk_bf16_f32 v65, v49, v53
  v_cvt_pk_bf16_f32 v66, v50, v54
  v_cvt_pk_bf16_f32 v67, v51, v55
  v_smfmac_f32_16x16x64_bf16 v[20:23], v[40:43], v[96:103], v1
  buffer_store_dwordx4 v[64:67], v2, s[8:11], s58 offen
  s_waitcnt lgkmcnt(0)
  v_smfmac_f32_16x16x64_bf16 v[16:19], v[32:35], v[104:111], v1
  v_smfmac_f32_16x16x64_bf16 v[20:23], v[32:35], v[24:31], v1
  s_nop 7
  v_cvt_pk_bf16_f32 v68, v16, v20
  v_cvt_pk_bf16_f32 v69, v17, v21
  v_cvt_pk_bf16_f32 v70, v18, v22
  v_cvt_pk_bf16_f32 v71, v19, v23
  buffer_store_dwordx4 v[68:71], v2, s[8:11], s59 offen
  s_cmp_ge_u32 s32, 2
  s_cbranch_scc1 c0_late
  ds_read_b128 v[72:75], v11 offset:6144
  ds_read_b128 v[76:79], v11 offset:7168
  ds_read_b128 v[80:83], v11 offset:8192
  ds_read_b128 v[84:87], v11 offset:9216
  ds_read_b128 v[88:91], v11 offset:10240
  ds_read_b128 v[92:95], v11 offset:11264
  ds_read_b128 v[96:99], v11 offset:12288
  ds_read_b128 v[100:103], v11 offset:13312
  ds_read_b128 v[104:107], v11 offset:14336
  ds_read_b128 v[108:111], v11 offset:15360
  ds_read_b128 v[24:27], v11 offset:0
  ds_read_b128 v[28:31], v11 offset:1024
  ds_read_b128 v[32:35], v11 offset:2048
  ds_read_b128 v[36:39], v11 offset:3072
  v_mov_b64 v[56:57], 0
  v_mov_b64 v[58:59], 0
  v_mov_b64 v[60:61], 0
  v_mov_b64 v[62:63], 0
  v_mov_b64 v[64:65], 0
  v_mov_b64 v[66:67], 0
  v_mov_b64 v[68:69], 0
  v_mov_b64 v[70:71], 0
  s_add_u32 s54, s54, 8192
  s_bitset0_b32 s54, 15
  s_add_u32 s56, s56, 8192
  s_add_u32 s57, s57, 16384
  s_add_u32 s60, s60, 0x40000
  s_and_b32 s60, s60, 0xc0000
  s_xor_b32 s64, s60, 0x80000
  s_add_u32 s64, s64, s65
  s_add_u32 s58, s60, 1048576
  s_add_u32 s59, s60, 1179648
  s_xor_b32 s69, s69, 16384
  s_add_u32 s34, s34, 1
  s_sleep 1
  buffer_load_dwordx4 v[48:51], v0, s[8:11], s62 offen offset:0 sc1
  buffer_load_dwordx4 v[52:55], v0, s[8:11], s62 offen offset:1024 sc1
  buffer_load_dwordx4 v[16:19], v0, s[8:11], s62 offen offset:2048 sc1
  buffer_load_dwordx4 v[20:23], v0, s[8:11], s62 offen offset:3072 sc1
  s_sleep 3
  buffer_load_dwordx4 v[48:51], v0, s[8:11], s62 offen offset:0 sc1
  buffer_load_dwordx4 v[52:55], v0, s[8:11], s62 offen offset:1024 sc1
  buffer_load_dwordx4 v[16:19], v0, s[8:11], s62 offen offset:2048 sc1
  buffer_load_dwordx4 v[20:23], v0, s[8:11], s62 offen offset:3072 sc1
  v_mov_b64 v[40:41], 0
  v_mov_b64 v[42:43], 0
c0_chkB:
  s_waitcnt vmcnt(6)
  s_nop 0
  v_smfmac_f32_16x16x64_bf16 v[40:43], v[44:47], v[48:55], v1
  s_waitcnt vmcnt(4)
  v_smfmac_f32_16x16x64_bf16 v[40:43], v[44:47], v[16:23], v1
  v_max3_u32 v12, v51, v55, v19
  v_max_u32 v12, v12, v23
  v_cmp_eq_u32 s[6:7], -1, v12
  s_nop 4
  v_cmp_u_f32 vcc, v42, v42
  v_add_f32_dpp v40, v40, v40 row_ror:8 row_mask:0xf bank_mask:0xf
  v_add_f32_dpp v41, v41, v41 row_ror:8 row_mask:0xf bank_mask:0xf
  v_cvt_pk_bf16_f32 v15, v40, v41
  s_cbranch_vccnz c0_reB
c0_okB:
  buffer_store_dword v15, v4, s[8:11], s55 offen
c0_join:
  v_cmp_le_u32 s[70:71], 4, v14
  s_cmp_eq_u32 s34, 63
  s_cbranch_scc1 c_done
  s_add_u32 s62, s63, s60
  s_add_u32 s55, s55, 8192
  s_bitset0_b32 s55, 15
  s_add_u32 s36, s34, 1
  s_bitcmp1_b64 s[70:71], s36
  s_cbranch_scc0 c0_kv_slow
c0_kv_ok:
  s_barrier
  s_sleep 1
  s_branch c0_top
c0_reA:
  s_cmp_eq_u32 s3, 2
  s_cbranch_scc1 c0_okA
  buffer_load_dwordx4 v[16:19], v0, s[8:11], s54 offen offset:0 sc1
  buffer_load_dwordx4 v[20:23], v0, s[8:11], s54 offen offset:1024 sc1
  s_nop 1
  v_mov_b64 v[64:65], 0
  v_mov_b64 v[66:67], 0
  v_mov_b64 v[68:69], 0
  v_mov_b64 v[70:71], 0
  v_mov_b64 v[56:57], 0
  v_mov_b64 v[58:59], 0
  v_mov_b64 v[60:61], 0
  v_mov_b64 v[62:63], 0
  s_cmp_eq_u32 s3, 0
  s_mov_b32 s3, 1
  s_cbranch_scc1 c0_chkA
c0_scnA:
  s_waitcnt vmcnt(2)
  v_max3_u32 v12, v16, v17, v18
  v_max3_u32 v13, v19, v20, v21
  v_max3_u32 v12, v12, v22, v23
  v_max_u32 v12, v12, v13
  v_cmp_eq_u32 vcc, -1, v12
  s_mov_b32 s3, 2
  s_cbranch_vccz c0_chkA
  s_mov_b64 exec, vcc
  buffer_load_dwordx4 v[16:19], v0, s[8:11], s54 offen offset:0 sc1
  buffer_load_dwordx4 v[20:23], v0, s[8:11], s54 offen offset:1024 sc1
  s_mov_b64 exec, -1
  s_sub_u32 s35, s35, 1
  s_cbranch_scc0 c0_scnA
  s_mov_b32 s35, 0
  s_branch c0_chkA
c0_reB:
  s_cmp_eq_u64 s[6:7], 0
  s_cbranch_scc1 c0_nan
  s_mov_b64 exec, s[6:7]
  buffer_load_dwordx4 v[48:51], v0, s[8:11], s62 offen offset:0 sc1
  buffer_load_dwordx4 v[52:55], v0, s[8:11], s62 offen offset:1024 sc1
  buffer_load_dwordx4 v[16:19], v0, s[8:11], s62 offen offset:2048 sc1
  buffer_load_dwordx4 v[20:23], v0, s[8:11], s62 offen offset:3072 sc1
  s_mov_b64 exec, -1
  v_mov_b64 v[40:41], 0
  v_mov_b64 v[42:43], 0
  s_sub_u32 s35, s35, 1
  s_cbranch_scc0 c0_chkB
  s_mov_b32 s35, 0
c0_nan:
  s_waitcnt vmcnt(0)
  v_max3_u32 v12, v48, v49, v50
  v_max3_u32 v12, v12, v51, v52
  v_max3_u32 v12, v12, v53, v54
  v_max3_u32 v12, v12, v55, v16
  v_max3_u32 v12, v12, v17, v18
  v_max3_u32 v12, v12, v19, v20
  v_max3_u32 v12, v12, v21, v22
  v_max_u32 v12, v12, v23
  v_cmp_eq_u32 vcc, -1, v12
  s_cbranch_vccz c0_nan2
  buffer_load_dwordx4 v[48:51], v0, s[8:11], s62 offen offset:0 sc1
  buffer_load_dwordx4 v[52:55], v0, s[8:11], s62 offen offset:1024 sc1
  buffer_load_dwordx4 v[16:19], v0, s[8:11], s62 offen offset:2048 sc1
  buffer_load_dwordx4 v[20:23], v0, s[8:11], s62 offen offset:3072 sc1
  s_sub_u32 s35, s35, 1
  s_cbranch_scc0 c0_nan
  s_mov_b32 s35, 0
c0_nan2:
  v_mov_b64 v[40:41], 0
  v_mov_b64 v[42:43], 0
  s_nop 1
  v_smfmac_f32_16x16x64_bf16 v[40:43], v[44:47], v[48:55], v1
  v_smfmac_f32_16x16x64_bf16 v[40:43], v[44:47], v[16:23], v1
  s_nop 7
  v_add_f32_dpp v40, v40, v40 row_ror:8 row_mask:0xf bank_mask:0xf
  v_add_f32_dpp v41, v41, v41 row_ror:8 row_mask:0xf bank_mask:0xf
  v_cvt_pk_bf16_f32 v15, v40, v41
  s_branch c0_okB
c0_late:
  ds_read_b128 v[72:75], v11 offset:6144
  ds_read_b128 v[76:79], v11 offset:7168
  ds_read_b128 v[80:83], v11 offset:8192
  ds_read_b128 v[84:87], v11 offset:9216
  ds_read_b128 v[88:91], v11 offset:10240
  ds_read_b128 v[92:95], v11 offset:11264
  ds_read_b128 v[96:99], v11 offset:12288
  ds_read_b128 v[100:103], v11 offset:13312
  ds_read_b128 v[104:107], v11 offset:14336
  ds_read_b128 v[108:111], v11 offset:15360
  ds_read_b128 v[24:27], v11 offset:0
  ds_read_b128 v[28:31], v11 offset:1024
  ds_read_b128 v[32:35], v11 offset:2048
  ds_read_b128 v[36:39], v11 offset:3072
  v_mov_b64 v[56:57], 0
  v_mov_b64 v[58:59], 0
  v_mov_b64 v[60:61], 0
  v_mov_b64 v[62:63], 0
  v_mov_b64 v[64:65], 0
  v_mov_b64 v[66:67], 0
  v_mov_b64 v[68:69], 0
  v_mov_b64 v[70:71], 0
  s_add_u32 s54, s54, 8192
  s_bitset0_b32 s54, 15
  s_add_u32 s56, s56, 8192
  s_add_u32 s57, s57, 16384
  s_add_u32 s60, s60, 0x40000
  s_and_b32 s60, s60, 0xc0000
  s_xor_b32 s64, s60, 0x80000
  s_add_u32 s64, s64, s65
  s_add_u32 s58, s60, 1048576
  s_add_u32 s59, s60, 1179648
  s_xor_b32 s69, s69, 16384
  s_add_u32 s34, s34, 1
  s_add_u32 s36, s55, 16384
  s_bitset0_b32 s36, 15
  ds_read_b32 v15, v4 offset:0
  v_mov_b32 v12, -1
  s_sub_u32 s37, s56, 8192
  s_mov_b64 exec, s[80:81]
  buffer_store_dword v12, v4, s[8:11], s36 offen
  s_waitcnt vmcnt(0) lgkmcnt(0)
  s_mov_b64 exec, -1
  s_branch c0_join
  s_branch cx0_top
.p2align 8
.fill 2, 4, 0xbf800000
cx0_top:
  s_sub_u32 m0, s67, s69
  s_mov_b32 s3, 0
  buffer_load_dwordx4 v[16:19], v0, s[8:11], s54 offen offset:0 sc1
  buffer_load_dwordx4 v[20:23], v0, s[8:11], s54 offen offset:1024 sc1
  ds_read_b128 v[40:43], v11 offset:4096
  ds_read_b128 v[44:47], v11 offset:5120
  s_sleep 3
  buffer_load_dwordx4 v[16:19], v0, s[8:11], s54 offen offset:0 sc1
  buffer_load_dwordx4 v[20:23], v0, s[8:11], s54 offen offset:1024 sc1
  s_waitcnt lgkmcnt(0)
cx0_chkA:
  s_waitcnt vmcnt(3)
  v_smfmac_f32_16x16x64_bf16 v[64:67], v[16:19], v[24:31], v1
  ds_write_b128 v7, v[16:19] offset:0
  s_waitcnt vmcnt(2)
  v_mov_b64 v[48:49], 0
  v_smfmac_f32_16x16x64_bf16 v[64:67], v[20:23], v[40:47], v1
  ds_write_b128 v7, v[20:23] offset:1024
  v_smfmac_f32_16x16x64_bf16 v[68:71], v[16:19], v[32:39], v1
  v_mov_b64 v[50:51], 0
  v_smfmac_f32_16x16x64_bf16 v[68:71], v[20:23], v[72:79], v1
  v_mov_b64 v[52:53], 0
  v_smfmac_f32_16x16x64_bf16 v[56:59], v[16:19], v[80:87], v1
  s_nop 1
  v_cmp_u_f32 vcc, v64, v65
  v_cmp_u_f32 s[6:7], v66, v67
  v_smfmac_f32_16x16x64_bf16 v[60:63], v[16:19], v[88:95], v1
  s_or_b64 vcc, vcc, s[6:7]
  s_cbranch_scc1 cx0_reA
cx0_okA:
  v_smfmac_f32_16x16x64_bf16 v[56:59], v[20:23], v[96:103], v1
  v_mov_b64 v[54:55], 0
  v_smfmac_f32_16x16x64_bf16 v[60:63], v[20:23], v[104:111], v1
  s_waitcnt vmcnt(0)
  s_waitcnt lgkmcnt(0)
  s_barrier
  v_smfmac_f32_16x16x64_bf16 v[48:51], v[16:19], a[0:7], v1
  ds_read_b128 v[24:27], v8 offset:0
  buffer_load_dwordx4 v0, s[8:11], s57 offen offset:0 sc1 lds
  v_add_u32 v12, s69, v0
  v_smfmac_f32_16x16x64_bf16 v[52:55], v[16:19], a[8:15], v1
  ds_read_b128 v[28:31], v9 offset:0
  v_smfmac_f32_16x16x64_bf16 v[48:51], v[20:23], a[16:23], v1
  ds_read_b128 v[32:35], v10 offset:0
  v_smfmac_f32_16x16x64_bf16 v[52:55], v[20:23], a[24:31], v1
  ds_read_b128 v[36:39], v8 offset:1024
  s_waitcnt lgkmcnt(3)
  v_smfmac_f32_16x16x64_bf16 v[48:51], v[24:27], a[32:39], v1
  ds_read_b128 v[40:43], v9 offset:1024
  buffer_load_dwordx4 v0, s[8:11], s57 offen offset:1024 sc1 lds
  v_smfmac_f32_16x16x64_bf16 v[52:55], v[24:27], a[40:47], v1
  ds_read_b128 v[44:47], v10 offset:1024
  s_waitcnt lgkmcnt(4)
  v_smfmac_f32_16x16x64_bf16 v[48:51], v[28:31], a[64:71], v1
  ds_read_b128 v[72:75], v12 offset:16384
  v_smfmac_f32_16x16x64_bf16 v[52:55], v[28:31], a[72:79], v1
  ds_read_b128 v[76:79], v12 offset:20480
  s_waitcnt lgkmcnt(5)
  v_smfmac_f32_16x16x64_bf16 v[48:51], v[32:35], a[96:103], v1
  ds_read_b128 v[80:83], v12 offset:17408
  buffer_load_dwordx4 v0, s[8:11], s57 offen offset:2048 sc1 lds
  v_mov_b64 v[16:17], -1
  v_smfmac_f32_16x16x64_bf16 v[52:55], v[32:35], a[104:111], v1
  ds_read_b128 v[84:87], v12 offset:21504
  s_waitcnt lgkmcnt(6)
  v_mov_b64 v[18:19], -1
  v_smfmac_f32_16x16x64_bf16 v[48:51], v[36:39], a[48:55], v1
  ds_read_b128 v[88:91], v12 offset:18432
  v_smfmac_f32_16x16x64_bf16 v[52:55], v[36:39], a[56:63], v1
  ds_read_b128 v[92:95], v12 offset:22528
  s_waitcnt lgkmcnt(7)
  v_smfmac_f32_16x16x64_bf16 v[48:51], v[40:43], a[80:87], v1
  ds_read_b128 v[96:99], v12 offset:19456
  buffer_load_dwordx4 v0, s[8:11], s57 offen offset:3072 sc1 lds
  v_smfmac_f32_16x16x64_bf16 v[52:55], v[40:43], a[88:95], v1
  ds_read_b128 v[100:103], v12 offset:23552
  s_waitcnt lgkmcnt(8)
  v_lshrrev_b32 v13, 2, v0
  v_smfmac_f32_16x16x64_bf16 v[48:51], v[44:47], a[112:119], v1
  buffer_load_dword v14, v13, s[8:11], s88 offen sc1
  buffer_store_dwordx4 v[16:19], v0, s[8:11], s64 offen sc1
  v_add_u32 v13, s69, v7
  v_smfmac_f32_16x16x64_bf16 v[52:55], v[44:47], a[120:127], v1
  v_smfmac_f32_16x16x64_bf16 v[56:59], v[24:27], a[128:135], v1
  ds_read_b128 v[104:107], v13 offset:24576
  v_smfmac_f32_16x16x64_bf16 v[60:63], v[24:27], a[136:143], v1
  buffer_store_dword v15, v4, s[8:11], s56 offen sc1
  v_smfmac_f32_16x16x64_bf16 v[56:59], v[28:31], a[160:167], v1
  ds_read_b128 v[108:111], v13 offset:25600
  s_nop 1
  v_permlane32_swap_b32 v48, v52
  v_smfmac_f32_16x16x64_bf16 v[60:63], v[28:31], a[168:175], v1
  v_permlane32_swap_b32 v49, v53
  v_smfmac_f32_16x16x64_bf16 v[56:59], v[32:35], a[192:199], v1
  v_permlane32_swap_b32 v50, v54
  v_smfmac_f32_16x16x64_bf16 v[60:63], v[32:35], a[200:207], v1
  buffer_store_dwordx4 v[16:19], v0, s[8:11], s64 offen offset:1024 sc1
  v_permlane32_swap_b32 v51, v55
  v_smfmac_f32_16x16x64_bf16 v[56:59], v[36:39], a[144:151], v1
  v_add_f32 v48, v48, v52
  v_smfmac_f32_16x16x64_bf16 v[60:63], v[36:39], a[152:159], v1
  v_add_f32 v49, v49, v53
  v_smfmac_f32_16x16x64_bf16 v[56:59], v[40:43], a[176:183], v1
  v_add_f32 v50, v50, v54
  v_add_f32 v51, v51, v55
  v_smfmac_f32_16x16x64_bf16 v[60:63], v[40:43], a[184:191], v1
  v_mul_f32 v48, s68, v48
  v_smfmac_f32_16x16x64_bf16 v[56:59], v[44:47], a[208:215], v1
  v_mul_f32 v49, s68, v49
  v_mul_f32 v50, s68, v50
  v_smfmac_f32_16x16x64_bf16 v[60:63], v[44:47], a[216:223], v1
  v_mul_f32 v51, s68, v51
  v_smfmac_f32_16x16x64_bf16 v[64:67], v[24:27], a[224:231], v1
  v_cvt_pk_bf16_f32 v12, v48, v49
  v_cvt_pk_bf16_f32 v13, v50, v51
  v_smfmac_f32_16x16x64_bf16 v[68:71], v[24:27], a[232:239], v1
  ds_write_b64 v5, v[12:13] offset:9216
  v_smfmac_f32_16x16x64_bf16 v[64:67], v[28:31], v[112:119], v1
  s_nop 0
  v_permlane32_swap_b32 v56, v60
  v_permlane32_swap_b32 v57, v61
  v_smfmac_f32_16x16x64_bf16 v[68:71], v[28:31], v[120:127], v1
  v_permlane32_swap_b32 v58, v62
  v_permlane32_swap_b32 v59, v63
  v_smfmac_f32_16x16x64_bf16 v[64:67], v[32:35], v[144:151], v1
  v_add_f32 v56, v56, v60
  v_smfmac_f32_16x16x64_bf16 v[68:71], v[32:35], v[152:159], v1
  s_waitcnt lgkmcnt(0)
  s_barrier
  v_add_f32 v57, v57, v61
  v_add_f32 v58, v58, v62
  v_smfmac_f32_16x16x64_bf16 v[64:67], v[36:39], a[240:247], v1
  ds_read_b64_tr_b16 v[48:49], v6 offset:9216
  ds_read_b64_tr_b16 v[50:51], v6 offset:9472
  v_add_f32 v59, v59, v63
  v_cvt_pk_bf16_f32 v12, v56, v57
  v_smfmac_f32_16x16x64_bf16 v[68:71], v[36:39], a[248:255], v1
  ds_read_b64_tr_b16 v[52:53], v6 offset:11264
  ds_read_b64_tr_b16 v[54:55], v6 offset:11520
  v_cvt_pk_bf16_f32 v13, v58, v59
  v_smfmac_f32_16x16x64_bf16 v[64:67], v[40:43], v[128:135], v1
  ds_write_b64 v5, v[12:13] offset:9728
  v_smfmac_f32_16x16x64_bf16 v[68:71], v[40:43], v[136:143], v1
  ds_read_b64_tr_b16 v[16:17], v6 offset:13312
  ds_read_b64_tr_b16 v[18:19], v6 offset:13568
  v_smfmac_f32_16x16x64_bf16 v[64:67], v[44:47], v[160:167], v1
  ds_read_b64_tr_b16 v[20:21], v6 offset:15360
  ds_read_b64_tr_b16 v[22:23], v6 offset:15616
  v_smfmac_f32_16x16x64_bf16 v[68:71], v[44:47], v[168:175], v1
  s_waitcnt lgkmcnt(7)
  v_mfma_f32_16x16x32_bf16 v[56:59], v[72:75], v[48:51], 0
  v_mfma_f32_16x16x32_bf16 v[60:63], v[76:79], v[48:51], 0
  s_waitcnt lgkmcnt(5)
  s_waitcnt lgkmcnt(4)
  s_barrier
  v_mfma_f32_16x16x32_bf16 v[56:59], v[80:83], v[52:55], v[56:59]
  ds_read_b64_tr_b16 v[24:25], v6 offset:9728
  ds_read_b64_tr_b16 v[26:27], v6 offset:9984
  v_cvt_pk_bf16_f32 v44, v64, v65
  v_mfma_f32_16x16x32_bf16 v[60:63], v[84:87], v[52:55], v[60:63]
  ds_read_b64_tr_b16 v[28:29], v6 offset:11776
  ds_read_b64_tr_b16 v[30:31], v6 offset:12032
  v_cvt_pk_bf16_f32 v45, v66, v67
  s_waitcnt lgkmcnt(6)
  v_mfma_f32_16x16x32_bf16 v[56:59], v[88:91], v[16:19], v[56:59]
  ds_read_b64_tr_b16 v[32:33], v6 offset:13824
  ds_read_b64_tr_b16 v[34:35], v6 offset:14080
  v_mfma_f32_16x16x32_bf16 v[60:63], v[92:95], v[16:19], v[60:63]
  ds_read_b64_tr_b16 v[36:37], v6 offset:15872
  ds_read_b64_tr_b16 v[38:39], v6 offset:16128
  s_waitcnt lgkmcnt(8)
  v_mfma_f32_16x16x32_bf16 v[56:59], v[96:99], v[20:23], v[56:59]
  ds_read_b128 v[72:75], v11 offset:16384
  v_cvt_pk_bf16_f32 v46, v68, v69
  v_mfma_f32_16x16x32_bf16 v[60:63], v[100:103], v[20:23], v[60:63]
  ds_read_b128 v[76:79], v11 offset:17408
  v_cvt_pk_bf16_f32 v47, v70, v71
  s_waitcnt lgkmcnt(8)
  v_mfma_f32_16x16x32_bf16 v[40:43], v[24:27], v[48:51], 0
  ds_read_b128 v[80:83], v11 offset:18432
  v_mov_b64 v[24:25], s[86:87]
  s_waitcnt lgkmcnt(7)
  v_mfma_f32_16x16x32_bf16 v[40:43], v[28:31], v[52:55], v[40:43]
  ds_read_b128 v[84:87], v11 offset:19456
  v_max3_f32 v12, v56, v57, v58
  s_waitcnt lgkmcnt(6)
  v_mfma_f32_16x16x32_bf16 v[40:43], v[32:35], v[16:19], v[40:43]
  ds_read_b128 v[88:91], v11 offset:20480
  v_max3_f32 v13, v59, v60, v61
  s_waitcnt lgkmcnt(5)
  v_mfma_f32_16x16x32_bf16 v[40:43], v[36:39], v[20:23], v[40:43]
  ds_read_b128 v[92:95], v11 offset:21504
  v_max3_f32 v12, v12, v62, v63
  v_max_f32 v12, v12, v13
  v_mov_b32 v13, v12
  v_mov_b64 v[26:27], s[86:87]
  v_cndmask_b32 v28, 0, v24, s[82:83]
  v_permlane32_swap_b32 v12, v13
  v_cndmask_b32 v29, 0, v24, s[82:83]
  v_max3_f32 v12, v12, v13, v40
  v_max3_f32 v13, v41, v42, v43
  v_max_f32 v12, v12, v13
  v_mov_b32 v13, v12
  v_mov_b64 v[48:49], 0
  v_mov_b64 v[50:51], 0
  v_permlane16_swap_b32 v12, v13
  v_max_f32 v12, v12, v13
  v_sub_f32 v56, v56, v12
  v_sub_f32 v57, v57, v12
  v_sub_f32 v58, v58, v12
  v_sub_f32 v59, v59, v12
  v_sub_f32 v60, v60, v12
  v_sub_f32 v61, v61, v12
  v_sub_f32 v62, v62, v12
  v_sub_f32 v63, v63, v12
  v_exp_f32 v56, v56
  v_exp_f32 v57, v57
  v_exp_f32 v58, v58
  v_exp_f32 v59, v59
  v_exp_f32 v60, v60
  v_exp_f32 v61, v61
  v_exp_f32 v62, v62
  v_exp_f32 v63, v63
  v_cvt_pk_bf16_f32 v32, v56, v57
  v_cvt_pk_bf16_f32 v33, v58, v59
  v_cvt_pk_bf16_f32 v34, v60, v61
  v_cvt_pk_bf16_f32 v35, v62, v63
  v_sub_f32 v40, v40, v12
  v_sub_f32 v41, v41, v12
  v_mfma_f32_16x16x32_bf16 v[36:39], v[24:27], v[32:35], 0
  ds_read_b128 v[96:99], v11 offset:22528
  v_sub_f32 v42, v42, v12
  v_sub_f32 v43, v43, v12
  v_mfma_f32_16x16x32_bf16 v[64:67], v[104:107], v[32:35], 0
  ds_read_b128 v[100:103], v11 offset:23552
  v_exp_f32 v40, v40
  v_mfma_f32_16x16x32_bf16 v[68:71], v[108:111], v[32:35], 0
  v_exp_f32 v41, v41
  v_exp_f32 v42, v42
  v_exp_f32 v43, v43
  v_cvt_pk_bf16_f32 v30, v40, v41
  v_cvt_pk_bf16_f32 v31, v42, v43
  v_mov_b64 v[52:53], 0
  v_mov_b64 v[54:55], 0
  v_mfma_f32_16x16x16_bf16 v[36:39], v[28:29], v[30:31], v[36:39]
  v_mov_b64 v[16:17], 0
  v_mov_b64 v[18:19], 0
  v_mfma_f32_16x16x16_bf16 v[64:67], v[44:45], v[30:31], v[64:67]
  v_mov_b64 v[20:21], 0
  v_mov_b64 v[22:23], 0
  v_mfma_f32_16x16x16_bf16 v[68:71], v[46:47], v[30:31], v[68:71]
  s_nop 1
  v_rcp_f32 v12, v36
  s_nop 1
  v_mul_f32 v64, v64, v12
  v_mul_f32 v65, v65, v12
  v_mul_f32 v66, v66, v12
  v_mul_f32 v67, v67, v12
  v_cvt_pk_bf16_f32 v56, v64, v65
  v_cvt_pk_bf16_f32 v57, v66, v67
  v_mul_f32 v68, v68, v12
  v_mul_f32 v69, v69, v12
  v_mul_f32 v70, v70, v12
  v_mul_f32 v71, v71, v12
  v_cvt_pk_bf16_f32 v58, v68, v69
  v_cvt_pk_bf16_f32 v59, v70, v71
  ds_write_b128 v7, v[56:59] offset:8192
  s_nop 0
  v_smfmac_f32_16x16x64_bf16 v[48:51], v[56:59], v[176:183], v1
  v_cndmask_b32 v44, 0, v3, s[72:73]
  v_smfmac_f32_16x16x64_bf16 v[52:55], v[56:59], v[184:191], v1
  v_cndmask_b32 v45, 0, v3, s[74:75]
  v_smfmac_f32_16x16x64_bf16 v[16:19], v[56:59], v[192:199], v1
  v_cndmask_b32 v46, 0, v3, s[72:73]
  v_smfmac_f32_16x16x64_bf16 v[20:23], v[56:59], v[200:207], v1
  v_cndmask_b32 v47, 0, v3, s[74:75]
  s_waitcnt lgkmcnt(0)
  s_barrier
  ds_read_b128 v[60:63], v8 offset:8192
  ds_read_b128 v[40:43], v9 offset:8192
  ds_read_b128 v[32:35], v10 offset:8192
  s_waitcnt lgkmcnt(2)
  v_smfmac_f32_16x16x64_bf16 v[48:51], v[60:63], v[208:215], v1
  ds_read_b128 v[104:107], v11 offset:24576
  v_smfmac_f32_16x16x64_bf16 v[52:55], v[60:63], v[216:223], v1
  ds_read_b128 v[108:111], v11 offset:25600
  s_waitcnt lgkmcnt(3)
  v_smfmac_f32_16x16x64_bf16 v[48:51], v[40:43], v[224:231], v1
  ds_read_b128 v[24:27], v11 offset:26624
  v_smfmac_f32_16x16x64_bf16 v[52:55], v[40:43], v[232:239], v1
  ds_read_b128 v[28:31], v11 offset:27648
  s_waitcnt lgkmcnt(4)
  v_smfmac_f32_16x16x64_bf16 v[48:51], v[32:35], v[240:247], v1
  v_smfmac_f32_16x16x64_bf16 v[52:55], v[32:35], v[248:255], v1
  v_smfmac_f32_16x16x64_bf16 v[16:19], v[60:63], v[72:79], v1
  v_smfmac_f32_16x16x64_bf16 v[20:23], v[60:63], v[80:87], v1
  v_smfmac_f32_16x16x64_bf16 v[16:19], v[40:43], v[88:95], v1
  s_nop 4
  v_cvt_pk_bf16_f32 v64, v48, v52
  v_cvt_pk_bf16_f32 v65, v49, v53
  v_cvt_pk_bf16_f32 v66, v50, v54
  v_cvt_pk_bf16_f32 v67, v51, v55
  v_smfmac_f32_16x16x64_bf16 v[20:23], v[40:43], v[96:103], v1
  buffer_store_dwordx4 v[64:67], v2, s[8:11], s58 offen sc1
  s_waitcnt lgkmcnt(0)
  v_smfmac_f32_16x16x64_bf16 v[16:19], v[32:35], v[104:111], v1
  v_smfmac_f32_16x16x64_bf16 v[20:23], v[32:35], v[24:31], v1
  s_nop 7
  v_cvt_pk_bf16_f32 v68, v16, v20
  v_cvt_pk_bf16_f32 v69, v17, v21
  v_cvt_pk_bf16_f32 v70, v18, v22
  v_cvt_pk_bf16_f32 v71, v19, v23
  buffer_store_dwordx4 v[68:71], v2, s[8:11], s59 offen sc1
  s_cmp_ge_u32 s32, 2
  s_cbranch_scc1 cx0_late
  ds_read_b128 v[72:75], v11 offset:6144
  ds_read_b128 v[76:79], v11 offset:7168
  ds_read_b128 v[80:83], v11 offset:8192
  ds_read_b128 v[84:87], v11 offset:9216
  ds_read_b128 v[88:91], v11 offset:10240
  ds_read_b128 v[92:95], v11 offset:11264
  ds_read_b128 v[96:99], v11 offset:12288
  ds_read_b128 v[100:103], v11 offset:13312
  ds_read_b128 v[104:107], v11 offset:14336
  ds_read_b128 v[108:111], v11 offset:15360
  ds_read_b128 v[24:27], v11 offset:0
  ds_read_b128 v[28:31], v11 offset:1024
  ds_read_b128 v[32:35], v11 offset:2048
  ds_read_b128 v[36:39], v11 offset:3072
  v_mov_b64 v[56:57], 0
  v_mov_b64 v[58:59], 0
  v_mov_b64 v[60:61], 0
  v_mov_b64 v[62:63], 0
  v_mov_b64 v[64:65], 0
  v_mov_b64 v[66:67], 0
  v_mov_b64 v[68:69], 0
  v_mov_b64 v[70:71], 0
  s_add_u32 s54, s54, 8192
  s_bitset0_b32 s54, 15
  s_add_u32 s56, s56, 8192
  s_add_u32 s57, s57, 16384
  s_add_u32 s60, s60, 0x40000
  s_and_b32 s60, s60, 0xc0000
  s_xor_b32 s64, s60, 0x80000
  s_add_u32 s64, s64, s65
  s_add_u32 s58, s60, 1048576
  s_add_u32 s59, s60, 1179648
  s_xor_b32 s69, s69, 16384
  s_add_u32 s34, s34, 1
  s_sleep 1
  buffer_load_dwordx4 v[48:51], v0, s[8:11], s62 offen offset:0 sc1
  buffer_load_dwordx4 v[52:55], v0, s[8:11], s62 offen offset:1024 sc1
  buffer_load_dwordx4 v[16:19], v0, s[8:11], s62 offen offset:2048 sc1
  buffer_load_dwordx4 v[20:23], v0, s[8:11], s62 offen offset:3072 sc1
  s_sleep 3
  buffer_load_dwordx4 v[48:51], v0, s[8:11], s62 offen offset:0 sc1
  buffer_load_dwordx4 v[52:55], v0, s[8:11], s62 offen offset:1024 sc1
  buffer_load_dwordx4 v[16:19], v0, s[8:11], s62 offen offset:2048 sc1
  buffer_load_dwordx4 v[20:23], v0, s[8:11], s62 offen offset:3072 sc1
  v_mov_b64 v[40:41], 0
  v_mov_b64 v[42:43], 0
cx0_chkB:
  s_waitcnt vmcnt(6)
  s_nop 0
  v_smfmac_f32_16x16x64_bf16 v[40:43], v[44:47], v[48:55], v1
  s_waitcnt vmcnt(4)
  v_smfmac_f32_16x16x64_bf16 v[40:43], v[44:47], v[16:23], v1
  v_max3_u32 v12, v51, v55, v19
  v_max_u32 v12, v12, v23
  v_cmp_eq_u32 s[6:7], -1, v12
  s_nop 4
  v_cmp_u_f32 vcc, v42, v42
  v_add_f32_dpp v40, v40, v40 row_ror:8 row_mask:0xf bank_mask:0xf
  v_add_f32_dpp v41, v41, v41 row_ror:8 row_mask:0xf bank_mask:0xf
  v_cvt_pk_bf16_f32 v15, v40, v41
  s_cbranch_vccnz cx0_reB
cx0_okB:
  buffer_store_dword v15, v4, s[8:11], s55 offen sc1
cx0_join:
  v_cmp_le_u32 s[70:71], 4, v14
  s_cmp_eq_u32 s34, 63
  s_cbranch_scc1 c_done
  s_add_u32 s62, s63, s60
  s_add_u32 s55, s55, 8192
  s_bitset0_b32 s55, 15
  s_add_u32 s36, s34, 1
  s_bitcmp1_b64 s[70:71], s36
  s_cbranch_scc0 cx0_kv_slow
cx0_kv_ok:
  s_barrier
  s_sleep 1
  s_branch cx0_top
cx0_reA:
  s_cmp_eq_u32 s3, 2
  s_cbranch_scc1 cx0_okA
  buffer_load_dwordx4 v[16:19], v0, s[8:11], s54 offen offset:0 sc1
  buffer_load_dwordx4 v[20:23], v0, s[8:11], s54 offen offset:1024 sc1
  s_nop 1
  v_mov_b64 v[64:65], 0
  v_mov_b64 v[66:67], 0
  v_mov_b64 v[68:69], 0
  v_mov_b64 v[70:71], 0
  v_mov_b64 v[56:57], 0
  v_mov_b64 v[58:59], 0
  v_mov_b64 v[60:61], 0
  v_mov_b64 v[62:63], 0
  s_cmp_eq_u32 s3, 0
  s_mov_b32 s3, 1
  s_cbranch_scc1 cx0_chkA
cx0_scnA:
  s_waitcnt vmcnt(2)
  v_max3_u32 v12, v16, v17, v18
  v_max3_u32 v13, v19, v20, v21
  v_max3_u32 v12, v12, v22, v23
  v_max_u32 v12, v12, v13
  v_cmp_eq_u32 vcc, -1, v12
  s_mov_b32 s3, 2
  s_cbranch_vccz cx0_chkA
  s_mov_b64 exec, vcc
  buffer_load_dwordx4 v[16:19], v0, s[8:11], s54 offen offset:0 sc1
  buffer_load_dwordx4 v[20:23], v0, s[8:11], s54 offen offset:1024 sc1
  s_mov_b64 exec, -1
  s_sub_u32 s35, s35, 1
  s_cbranch_scc0 cx0_scnA
  s_mov_b32 s35, 0
  s_branch cx0_chkA
cx0_reB:
  s_cmp_eq_u64 s[6:7], 0
  s_cbranch_scc1 cx0_nan
  s_mov_b64 exec, s[6:7]
  buffer_load_dwordx4 v[48:51], v0, s[8:11], s62 offen offset:0 sc1
  buffer_load_dwordx4 v[52:55], v0, s[8:11], s62 offen offset:1024 sc1
  buffer_load_dwordx4 v[16:19], v0, s[8:11], s62 offen offset:2048 sc1
  buffer_load_dwordx4 v[20:23], v0, s[8:11], s62 offen offset:3072 sc1
  s_mov_b64 exec, -1
  v_mov_b64 v[40:41], 0
  v_mov_b64 v[42:43], 0
  s_sub_u32 s35, s35, 1
  s_cbranch_scc0 cx0_chkB
  s_mov_b32 s35, 0
cx0_nan:
  s_waitcnt vmcnt(0)
  v_max3_u32 v12, v48, v49, v50
  v_max3_u32 v12, v12, v51, v52
  v_max3_u32 v12, v12, v53, v54
  v_max3_u32 v12, v12, v55, v16
  v_max3_u32 v12, v12, v17, v18
  v_max3_u32 v12, v12, v19, v20
  v_max3_u32 v12, v12, v21, v22
  v_max_u32 v12, v12, v23
  v_cmp_eq_u32 vcc, -1, v12
  s_cbranch_vccz cx0_nan2
  buffer_load_dwordx4 v[48:51], v0, s[8:11], s62 offen offset:0 sc1
  buffer_load_dwordx4 v[52:55], v0, s[8:11], s62 offen offset:1024 sc1
  buffer_load_dwordx4 v[16:19], v0, s[8:11], s62 offen offset:2048 sc1
  buffer_load_dwordx4 v[20:23], v0, s[8:11], s62 offen offset:3072 sc1
  s_sub_u32 s35, s35, 1
  s_cbranch_scc0 cx0_nan
  s_mov_b32 s35, 0
cx0_nan2:
  v_mov_b64 v[40:41], 0
  v_mov_b64 v[42:43], 0
  s_nop 1
  v_smfmac_f32_16x16x64_bf16 v[40:43], v[44:47], v[48:55], v1
  v_smfmac_f32_16x16x64_bf16 v[40:43], v[44:47], v[16:23], v1
  s_nop 7
  v_add_f32_dpp v40, v40, v40 row_ror:8 row_mask:0xf bank_mask:0xf
  v_add_f32_dpp v41, v41, v41 row_ror:8 row_mask:0xf bank_mask:0xf
  v_cvt_pk_bf16_f32 v15, v40, v41
  s_branch cx0_okB
cx0_late:
  ds_read_b128 v[72:75], v11 offset:6144
  ds_read_b128 v[76:79], v11 offset:7168
  ds_read_b128 v[80:83], v11 offset:8192
  ds_read_b128 v[84:87], v11 offset:9216
  ds_read_b128 v[88:91], v11 offset:10240
  ds_read_b128 v[92:95], v11 offset:11264
  ds_read_b128 v[96:99], v11 offset:12288
  ds_read_b128 v[100:103], v11 offset:13312
  ds_read_b128 v[104:107], v11 offset:14336
  ds_read_b128 v[108:111], v11 offset:15360
  ds_read_b128 v[24:27], v11 offset:0
  ds_read_b128 v[28:31], v11 offset:1024
  ds_read_b128 v[32:35], v11 offset:2048
  ds_read_b128 v[36:39], v11 offset:3072
  v_mov_b64 v[56:57], 0
  v_mov_b64 v[58:59], 0
  v_mov_b64 v[60:61], 0
  v_mov_b64 v[62:63], 0
  v_mov_b64 v[64:65], 0
  v_mov_b64 v[66:67], 0
  v_mov_b64 v[68:69], 0
  v_mov_b64 v[70:71], 0
  s_add_u32 s54, s54, 8192
  s_bitset0_b32 s54, 15
  s_add_u32 s56, s56, 8192
  s_add_u32 s57, s57, 16384
  s_add_u32 s60, s60, 0x40000
  s_and_b32 s60, s60, 0xc0000
  s_xor_b32 s64, s60, 0x80000
  s_add_u32 s64, s64, s65
  s_add_u32 s58, s60, 1048576
  s_add_u32 s59, s60, 1179648
  s_xor_b32 s69, s69, 16384
  s_add_u32 s34, s34, 1
  s_add_u32 s36, s55, 16384
  s_bitset0_b32 s36, 15
  ds_read_b32 v15, v4 offset:0
  v_mov_b32 v12, -1
  s_sub_u32 s37, s56, 8192
  s_mov_b64 exec, s[80:81]
  buffer_store_dword v12, v4, s[8:11], s36 offen sc1
  s_waitcnt vmcnt(0) lgkmcnt(0)
  s_mov_b64 exec, -1
  s_branch cx0_join
c_kv0_slow:
  v_lshrrev_b32 v12, 2, v0
  s_lshl_b32 s37, s33, 8
  buffer_load_dword v13, v12, s[8:11], s37 offen sc1
  s_waitcnt vmcnt(0)
  v_cmp_le_u32 s[70:71], 4, v13
  s_nop 1
  s_bitcmp1_b64 s[70:71], s36
  s_cbranch_scc1 c_kv0_ok
  s_sub_u32 s35, s35, 1
  s_cbranch_scc0 c_kv0_slow
  s_mov_b32 s35, 0
  s_branch c_kv0_ok
c_kv1_slow:
  v_lshrrev_b32 v12, 2, v0
  s_lshl_b32 s37, s33, 8
  buffer_load_dword v13, v12, s[8:11], s37 offen sc1
  s_waitcnt vmcnt(0)
  v_cmp_le_u32 s[70:71], 4, v13
  s_nop 1
  s_bitcmp1_b64 s[70:71], s36
  s_cbranch_scc1 c_kv1_ok
  s_sub_u32 s35, s35, 1
  s_cbranch_scc0 c_kv1_slow
  s_mov_b32 s35, 0
  s_branch c_kv1_ok
c0_kv_slow:
  v_lshrrev_b32 v12, 2, v0
  s_lshl_b32 s37, s33, 8
  buffer_load_dword v13, v12, s[8:11], s37 offen sc1
  s_waitcnt vmcnt(0)
  v_cmp_le_u32 s[70:71], 4, v13
  s_nop 1
  s_bitcmp1_b64 s[70:71], s36
  s_cbranch_scc1 c0_kv_ok
  s_sub_u32 s35, s35, 1
  s_cbranch_scc0 c0_kv_slow
  s_mov_b32 s35, 0
  s_branch c0_kv_ok
cx0_kv_slow:
  v_lshrrev_b32 v12, 2, v0
  s_lshl_b32 s37, s33, 8
  buffer_load_dword v13, v12, s[8:11], s37 offen sc1
  s_waitcnt vmcnt(0)
  v_cmp_le_u32 s[70:71], 4, v13
  s_nop 1
  s_bitcmp1_b64 s[70:71], s36
  s_cbranch_scc1 cx0_kv_ok
  s_sub_u32 s35, s35, 1
  s_cbranch_scc0 cx0_kv_slow
  s_mov_b32 s35, 0
  s_branch cx0_kv_ok
c_done:
  s_cmp_ge_u32 s32, 2
  s_cbranch_scc1 c_fin
  s_mov_b64 exec, s[80:81]
  buffer_store_dword v15, v4, s[8:11], s56 offen sc1
  s_mov_b64 exec, -1
c_fin:
  s_endpgm
L_worker:
  v_and_b32 v1, 63, v0
  v_lshlrev_b32 v0, 4, v1
  s_mul_i32 s52, s32, 40960
  v_lshlrev_b32 v2, 3, v1
  v_add_u32 v2, s52, v2
  s_mov_b32 s35, 1000000
  s_cmp_lg_u32 s3, 1
  s_cbranch_scc1 L_w2
  s_lshl_b32 s90, s33, 1
  s_load_dwordx2 s[4:5], s[0:1], 0
  s_waitcnt lgkmcnt(0)
  s_mov_b32 s16, s4
  s_and_b32 s17, s5, 0xffff
  s_mov_b32 s18, 2097152
  s_mov_b32 s19, 0x20000
  v_lshlrev_b32 v4, 7, v1
ln_top:
  s_lshl_b32 s36, s90, 15
  s_lshl_b32 s37, s32, 13
  s_add_u32 s36, s36, s37
  buffer_load_dwordx4 v[16:19], v4, s[16:19], s36 offen offset:0
  buffer_load_dwordx4 v[20:23], v4, s[16:19], s36 offen offset:16
  buffer_load_dwordx4 v[24:27], v4, s[16:19], s36 offen offset:32
  buffer_load_dwordx4 v[28:31], v4, s[16:19], s36 offen offset:48
  buffer_load_dwordx4 v[32:35], v4, s[16:19], s36 offen offset:64
  buffer_load_dwordx4 v[36:39], v4, s[16:19], s36 offen offset:80
  buffer_load_dwordx4 v[40:43], v4, s[16:19], s36 offen offset:96
  buffer_load_dwordx4 v[44:47], v4, s[16:19], s36 offen offset:112
  s_xor_b32 s36, s36, 0x8000
  buffer_load_dword v112, v4, s[16:19], s36 offen
  buffer_load_dword v112, v4, s[16:19], s36 offen offset:64
  v_and_b32 v5, 7, v1
  v_lshlrev_b32 v5, 11, v5
  v_lshrrev_b32 v6, 3, v1
  v_lshl_add_u32 v5, v6, 4, v5
  s_lshl_b32 s36, s90, 15
  s_lshr_b32 s37, s32, 1
  s_lshl_b32 s37, s37, 14
  s_add_u32 s36, s36, s37
  s_and_b32 s37, s32, 1
  s_lshl_b32 s37, s37, 7
  s_add_u32 s36, s36, s37
  s_add_u32 s39, s36, 2097152
  s_mov_b32 s38, 0xffff0000
  s_waitcnt vmcnt(9)
  v_lshlrev_b32 v48, 16, v16
  v_and_b32 v49, s38, v16
  v_lshlrev_b32 v50, 16, v17
  v_and_b32 v51, s38, v17
  v_lshlrev_b32 v52, 16, v18
  v_and_b32 v53, s38, v18
  v_lshlrev_b32 v54, 16, v19
  v_and_b32 v55, s38, v19
  s_waitcnt vmcnt(8)
  v_lshlrev_b32 v56, 16, v20
  v_and_b32 v57, s38, v20
  v_lshlrev_b32 v58, 16, v21
  v_and_b32 v59, s38, v21
  v_lshlrev_b32 v60, 16, v22
  v_and_b32 v61, s38, v22
  v_lshlrev_b32 v62, 16, v23
  v_and_b32 v63, s38, v23
  s_waitcnt vmcnt(7)
  v_lshlrev_b32 v64, 16, v24
  v_and_b32 v65, s38, v24
  v_lshlrev_b32 v66, 16, v25
  v_and_b32 v67, s38, v25
  v_lshlrev_b32 v68, 16, v26
  v_and_b32 v69, s38, v26
  v_lshlrev_b32 v70, 16, v27
  v_and_b32 v71, s38, v27
  s_waitcnt vmcnt(6)
  v_lshlrev_b32 v72, 16, v28
  v_and_b32 v73, s38, v28
  v_lshlrev_b32 v74, 16, v29
  v_and_b32 v75, s38, v29
  v_lshlrev_b32 v76, 16, v30
  v_and_b32 v77, s38, v30
  v_lshlrev_b32 v78, 16, v31
  v_and_b32 v79, s38, v31
  s_waitcnt vmcnt(5)
  v_lshlrev_b32 v80, 16, v32
  v_and_b32 v81, s38, v32
  v_lshlrev_b32 v82, 16, v33
  v_and_b32 v83, s38, v33
  v_lshlrev_b32 v84, 16, v34
  v_and_b32 v85, s38, v34
  v_lshlrev_b32 v86, 16, v35
  v_and_b32 v87, s38, v35
  s_waitcnt vmcnt(4)
  v_lshlrev_b32 v88, 16, v36
  v_and_b32 v89, s38, v36
  v_lshlrev_b32 v90, 16, v37
  v_and_b32 v91, s38, v37
  v_lshlrev_b32 v92, 16, v38
  v_and_b32 v93, s38, v38
  v_lshlrev_b32 v94, 16, v39
  v_and_b32 v95, s38, v39
  s_waitcnt vmcnt(3)
  v_lshlrev_b32 v96, 16, v40
  v_and_b32 v97, s38, v40
  v_lshlrev_b32 v98, 16, v41
  v_and_b32 v99, s38, v41
  v_lshlrev_b32 v100, 16, v42
  v_and_b32 v101, s38, v42
  v_lshlrev_b32 v102, 16, v43
  v_and_b32 v103, s38, v43
  s_waitcnt vmcnt(2)
  v_lshlrev_b32 v104, 16, v44
  v_and_b32 v105, s38, v44
  v_lshlrev_b32 v106, 16, v45
  v_and_b32 v107, s38, v45
  v_lshlrev_b32 v108, 16, v46
  v_and_b32 v109, s38, v46
  v_lshlrev_b32 v110, 16, v47
  v_and_b32 v111, s38, v47
  v_add_f32 v8, v48, v52
  v_add_f32 v9, v49, v53
  v_add_f32 v10, v50, v54
  v_add_f32 v11, v51, v55
  v_add_f32 v8, v8, v56
  v_add_f32 v9, v9, v57
  v_add_f32 v10, v10, v58
  v_add_f32 v11, v11, v59
  v_add_f32 v8, v8, v60
  v_add_f32 v9, v9, v61
  v_add_f32 v10, v10, v62
  v_add_f32 v11, v11, v63
  v_add_f32 v8, v8, v64
  v_add_f32 v9, v9, v65
  v_add_f32 v10, v10, v66
  v_add_f32 v11, v11, v67
  v_add_f32 v8, v8, v68
  v_add_f32 v9, v9, v69
  v_add_f32 v10, v10, v70
  v_add_f32 v11, v11, v71
  v_add_f32 v8, v8, v72
  v_add_f32 v9, v9, v73
  v_add_f32 v10, v10, v74
  v_add_f32 v11, v11, v75
  v_add_f32 v8, v8, v76
  v_add_f32 v9, v9, v77
  v_add_f32 v10, v10, v78
  v_add_f32 v11, v11, v79
  v_add_f32 v8, v8, v80
  v_add_f32 v9, v9, v81
  v_add_f32 v10, v10, v82
  v_add_f32 v11, v11, v83
  v_add_f32 v8, v8, v84
  v_add_f32 v9, v9, v85
  v_add_f32 v10, v10, v86
  v_add_f32 v11, v11, v87
  v_add_f32 v8, v8, v88
  v_add_f32 v9, v9, v89
  v_add_f32 v10, v10, v90
  v_add_f32 v11, v11, v91
  v_add_f32 v8, v8, v92
  v_add_f32 v9, v9, v93
  v_add_f32 v10, v10, v94
  v_add_f32 v11, v11, v95
  v_add_f32 v8, v8, v96
  v_add_f32 v9, v9, v97
  v_add_f32 v10, v10, v98
  v_add_f32 v11, v11, v99
  v_add_f32 v8, v8, v100
  v_add_f32 v9, v9, v101
  v_add_f32 v10, v10, v102
  v_add_f32 v11, v11, v103
  v_add_f32 v8, v8, v104
  v_add_f32 v9, v9, v105
  v_add_f32 v10, v10, v106
  v_add_f32 v11, v11, v107
  v_add_f32 v8, v8, v108
  v_add_f32 v9, v9, v109
  v_add_f32 v10, v10, v110
  v_add_f32 v11, v11, v111
  v_add_f32 v8, v8, v9
  v_add_f32 v10, v10, v11
  v_add_f32 v8, v8, v10
  s_nop 1
  v_add_f32_dpp v8, v8, v8 quad_perm:[1,0,3,2] row_mask:0xf bank_mask:0xf
  s_nop 1
  v_add_f32_dpp v8, v8, v8 quad_perm:[2,3,0,1] row_mask:0xf bank_mask:0xf
  s_nop 1
  v_add_f32_dpp v8, v8, v8 row_half_mirror row_mask:0xf bank_mask:0xf
  v_mul_f32 v7, 989855744, v8
  v_mov_b32 v8, 0
  v_mov_b32 v9, 0
  v_mov_b32 v10, 0
  v_mov_b32 v11, 0
  v_sub_f32 v12, v48, v7
  v_fmac_f32 v8, v12, v12
  v_sub_f32 v13, v49, v7
  v_fmac_f32 v9, v13, v13
  v_sub_f32 v14, v50, v7
  v_fmac_f32 v10, v14, v14
  v_sub_f32 v15, v51, v7
  v_fmac_f32 v11, v15, v15
  v_sub_f32 v12, v52, v7
  v_fmac_f32 v8, v12, v12
  v_sub_f32 v13, v53, v7
  v_fmac_f32 v9, v13, v13
  v_sub_f32 v14, v54, v7
  v_fmac_f32 v10, v14, v14
  v_sub_f32 v15, v55, v7
  v_fmac_f32 v11, v15, v15
  v_sub_f32 v12, v56, v7
  v_fmac_f32 v8, v12, v12
  v_sub_f32 v13, v57, v7
  v_fmac_f32 v9, v13, v13
  v_sub_f32 v14, v58, v7
  v_fmac_f32 v10, v14, v14
  v_sub_f32 v15, v59, v7
  v_fmac_f32 v11, v15, v15
  v_sub_f32 v12, v60, v7
  v_fmac_f32 v8, v12, v12
  v_sub_f32 v13, v61, v7
  v_fmac_f32 v9, v13, v13
  v_sub_f32 v14, v62, v7
  v_fmac_f32 v10, v14, v14
  v_sub_f32 v15, v63, v7
  v_fmac_f32 v11, v15, v15
  v_sub_f32 v12, v64, v7
  v_fmac_f32 v8, v12, v12
  v_sub_f32 v13, v65, v7
  v_fmac_f32 v9, v13, v13
  v_sub_f32 v14, v66, v7
  v_fmac_f32 v10, v14, v14
  v_sub_f32 v15, v67, v7
  v_fmac_f32 v11, v15, v15
  v_sub_f32 v12, v68, v7
  v_fmac_f32 v8, v12, v12
  v_sub_f32 v13, v69, v7
  v_fmac_f32 v9, v13, v13
  v_sub_f32 v14, v70, v7
  v_fmac_f32 v10, v14, v14
  v_sub_f32 v15, v71, v7
  v_fmac_f32 v11, v15, v15
  v_sub_f32 v12, v72, v7
  v_fmac_f32 v8, v12, v12
  v_sub_f32 v13, v73, v7
  v_fmac_f32 v9, v13, v13
  v_sub_f32 v14, v74, v7
  v_fmac_f32 v10, v14, v14
  v_sub_f32 v15, v75, v7
  v_fmac_f32 v11, v15, v15
  v_sub_f32 v12, v76, v7
  v_fmac_f32 v8, v12, v12
  v_sub_f32 v13, v77, v7
  v_fmac_f32 v9, v13, v13
  v_sub_f32 v14, v78, v7
  v_fmac_f32 v10, v14, v14
  v_sub_f32 v15, v79, v7
  v_fmac_f32 v11, v15, v15
  v_sub_f32 v12, v80, v7
  v_fmac_f32 v8, v12, v12
  v_sub_f32 v13, v81, v7
  v_fmac_f32 v9, v13, v13
  v_sub_f32 v14, v82, v7
  v_fmac_f32 v10, v14, v14
  v_sub_f32 v15, v83, v7
  v_fmac_f32 v11, v15, v15
  v_sub_f32 v12, v84, v7
  v_fmac_f32 v8, v12, v12
  v_sub_f32 v13, v85, v7
  v_fmac_f32 v9, v13, v13
  v_sub_f32 v14, v86, v7
  v_fmac_f32 v10, v14, v14
  v_sub_f32 v15, v87, v7
  v_fmac_f32 v11, v15, v15
  v_sub_f32 v12, v88, v7
  v_fmac_f32 v8, v12, v12
  v_sub_f32 v13, v89, v7
  v_fmac_f32 v9, v13, v13
  v_sub_f32 v14, v90, v7
  v_fmac_f32 v10, v14, v14
  v_sub_f32 v15, v91, v7
  v_fmac_f32 v11, v15, v15
  v_sub_f32 v12, v92, v7
  v_fmac_f32 v8, v12, v12
  v_sub_f32 v13, v93, v7
  v_fmac_f32 v9, v13, v13
  v_sub_f32 v14, v94, v7
  v_fmac_f32 v10, v14, v14
  v_sub_f32 v15, v95, v7
  v_fmac_f32 v11, v15, v15
  v_sub_f32 v12, v96, v7
  v_fmac_f32 v8, v12, v12
  v_sub_f32 v13, v97, v7
  v_fmac_f32 v9, v13, v13
  v_sub_f32 v14, v98, v7
  v_fmac_f32 v10, v14, v14
  v_sub_f32 v15, v99, v7
  v_fmac_f32 v11, v15, v15
  v_sub_f32 v12, v100, v7
  v_fmac_f32 v8, v12, v12
  v_sub_f32 v13, v101, v7
  v_fmac_f32 v9, v13, v13
  v_sub_f32 v14, v102, v7
  v_fmac_f32 v10, v14, v14
  v_sub_f32 v15, v103, v7
  v_fmac_f32 v11, v15, v15
  v_sub_f32 v12, v104, v7
  v_fmac_f32 v8, v12, v12
  v_sub_f32 v13, v105, v7
  v_fmac_f32 v9, v13, v13
  v_sub_f32 v14, v106, v7
  v_fmac_f32 v10, v14, v14
  v_sub_f32 v15, v107, v7
  v_fmac_f32 v11, v15, v15
  v_sub_f32 v12, v108, v7
  v_fmac_f32 v8, v12, v12
  v_sub_f32 v13, v109, v7
  v_fmac_f32 v9, v13, v13
  v_sub_f32 v14, v110, v7
  v_fmac_f32 v10, v14, v14
  v_sub_f32 v15, v111, v7
  v_fmac_f32 v11, v15, v15
  v_add_f32 v8, v8, v9
  v_add_f32 v10, v10, v11
  v_add_f32 v8, v8, v10
  s_nop 1
  v_add_f32_dpp v8, v8, v8 quad_perm:[1,0,3,2] row_mask:0xf bank_mask:0xf
  s_nop 1
  v_add_f32_dpp v8, v8, v8 quad_perm:[2,3,0,1] row_mask:0xf bank_mask:0xf
  s_nop 1
  v_add_f32_dpp v8, v8, v8 row_half_mirror row_mask:0xf bank_mask:0xf
  v_mul_f32 v8, 989855744, v8
  v_cvt_pk_bf16_f32 v9, v7, v8
  v_lshlrev_b32 v7, 16, v9
  v_and_b32 v8, s38, v9
  v_add_f32 v8, 925353388, v8
  v_cvt_pk_bf16_f32 v8, v8, v8
  v_and_b32 v8, s38, v8
  v_sqrt_f32 v8, v8
  s_nop 0
  v_cvt_pk_bf16_f32 v8, v8, v8
  v_and_b32 v8, s38, v8
  v_rcp_f32 v8, v8
  s_cmp_lg_u32 s95, 0
  s_cbranch_scc1 ln_conf
  s_mov_b32 s95, 1
  s_barrier
  v_mov_b32 v14, 163836
  ds_read_b32 v14, v14
  s_waitcnt lgkmcnt(0)
  v_readfirstlane_b32 s36, v14
  s_barrier
  s_cmp_eq_u32 s36, s94
  s_cbranch_scc1 ln_conf
  s_mov_b32 s94, s36
  s_waitcnt vmcnt(0)
  s_barrier
  s_branch L_role
ln_conf:
  v_mov_b32 v12, -1
  v_mov_b32 v13, -1
  v_mov_b32 v14, -1
  v_mov_b32 v15, -1
  s_lshl_b32 s36, s90, 13
  s_lshl_b32 s37, s32, 11
  s_add_u32 s36, s36, s37
  s_add_u32 s36, s36, 524288
  buffer_store_dwordx4 v[12:15], v0, s[8:11], s36 offen sc1
  buffer_store_dwordx4 v[12:15], v0, s[8:11], s36 offen offset:1024 sc1
  s_lshl_b32 s36, s90, 9
  s_and_b32 s37, s32, 1
  s_lshl_b32 s37, s37, 8
  s_add_u32 s36, s36, s37
  v_mov_b32 v9, 0
  v_lshlrev_b32 v10, 2, v1
  buffer_store_dword v9, v10, s[8:11], s36 offen sc1
  v_sub_f32 v48, v48, v7
  v_sub_f32 v80, v80, v7
  v_cvt_pk_bf16_f32 v80, v48, v80
  v_lshlrev_b32 v48, 16, v80
  v_and_b32 v80, s38, v80
  v_mul_f32 v48, v48, v8
  v_mul_f32 v80, v80, v8
  v_cvt_pk_bf16_f32 v16, v48, v80
  v_sub_f32 v52, v52, v7
  v_sub_f32 v84, v84, v7
  v_cvt_pk_bf16_f32 v84, v52, v84
  v_lshlrev_b32 v52, 16, v84
  v_and_b32 v84, s38, v84
  v_mul_f32 v52, v52, v8
  v_mul_f32 v84, v84, v8
  v_cvt_pk_bf16_f32 v17, v52, v84
  v_sub_f32 v49, v49, v7
  v_sub_f32 v81, v81, v7
  v_cvt_pk_bf16_f32 v81, v49, v81
  v_lshlrev_b32 v49, 16, v81
  v_and_b32 v81, s38, v81
  v_mul_f32 v49, v49, v8
  v_mul_f32 v81, v81, v8
  v_cvt_pk_bf16_f32 v18, v49, v81
  v_sub_f32 v53, v53, v7
  v_sub_f32 v85, v85, v7
  v_cvt_pk_bf16_f32 v85, v53, v85
  v_lshlrev_b32 v53, 16, v85
  v_and_b32 v85, s38, v85
  v_mul_f32 v53, v53, v8
  v_mul_f32 v85, v85, v8
  v_cvt_pk_bf16_f32 v19, v53, v85
  buffer_store_dwordx4 v[16:19], v5, s[8:11], s39 offen offset:0 sc1
  v_sub_f32 v50, v50, v7
  v_sub_f32 v82, v82, v7
  v_cvt_pk_bf16_f32 v82, v50, v82
  v_lshlrev_b32 v50, 16, v82
  v_and_b32 v82, s38, v82
  v_mul_f32 v50, v50, v8
  v_mul_f32 v82, v82, v8
  v_cvt_pk_bf16_f32 v20, v50, v82
  v_sub_f32 v54, v54, v7
  v_sub_f32 v86, v86, v7
  v_cvt_pk_bf16_f32 v86, v54, v86
  v_lshlrev_b32 v54, 16, v86
  v_and_b32 v86, s38, v86
  v_mul_f32 v54, v54, v8
  v_mul_f32 v86, v86, v8
  v_cvt_pk_bf16_f32 v21, v54, v86
  v_sub_f32 v51, v51, v7
  v_sub_f32 v83, v83, v7
  v_cvt_pk_bf16_f32 v83, v51, v83
  v_lshlrev_b32 v51, 16, v83
  v_and_b32 v83, s38, v83
  v_mul_f32 v51, v51, v8
  v_mul_f32 v83, v83, v8
  v_cvt_pk_bf16_f32 v22, v51, v83
  v_sub_f32 v55, v55, v7
  v_sub_f32 v87, v87, v7
  v_cvt_pk_bf16_f32 v87, v55, v87
  v_lshlrev_b32 v55, 16, v87
  v_and_b32 v87, s38, v87
  v_mul_f32 v55, v55, v8
  v_mul_f32 v87, v87, v8
  v_cvt_pk_bf16_f32 v23, v55, v87
  buffer_store_dwordx4 v[20:23], v5, s[8:11], s39 offen offset:256 sc1
  v_sub_f32 v56, v56, v7
  v_sub_f32 v88, v88, v7
  v_cvt_pk_bf16_f32 v88, v56, v88
  v_lshlrev_b32 v56, 16, v88
  v_and_b32 v88, s38, v88
  v_mul_f32 v56, v56, v8
  v_mul_f32 v88, v88, v8
  v_cvt_pk_bf16_f32 v24, v56, v88
  v_sub_f32 v60, v60, v7
  v_sub_f32 v92, v92, v7
  v_cvt_pk_bf16_f32 v92, v60, v92
  v_lshlrev_b32 v60, 16, v92
  v_and_b32 v92, s38, v92
  v_mul_f32 v60, v60, v8
  v_mul_f32 v92, v92, v8
  v_cvt_pk_bf16_f32 v25, v60, v92
  v_sub_f32 v57, v57, v7
  v_sub_f32 v89, v89, v7
  v_cvt_pk_bf16_f32 v89, v57, v89
  v_lshlrev_b32 v57, 16, v89
  v_and_b32 v89, s38, v89
  v_mul_f32 v57, v57, v8
  v_mul_f32 v89, v89, v8
  v_cvt_pk_bf16_f32 v26, v57, v89
  v_sub_f32 v61, v61, v7
  v_sub_f32 v93, v93, v7
  v_cvt_pk_bf16_f32 v93, v61, v93
  v_lshlrev_b32 v61, 16, v93
  v_and_b32 v93, s38, v93
  v_mul_f32 v61, v61, v8
  v_mul_f32 v93, v93, v8
  v_cvt_pk_bf16_f32 v27, v61, v93
  buffer_store_dwordx4 v[24:27], v5, s[8:11], s39 offen offset:512 sc1
  v_sub_f32 v58, v58, v7
  v_sub_f32 v90, v90, v7
  v_cvt_pk_bf16_f32 v90, v58, v90
  v_lshlrev_b32 v58, 16, v90
  v_and_b32 v90, s38, v90
  v_mul_f32 v58, v58, v8
  v_mul_f32 v90, v90, v8
  v_cvt_pk_bf16_f32 v28, v58, v90
  v_sub_f32 v62, v62, v7
  v_sub_f32 v94, v94, v7
  v_cvt_pk_bf16_f32 v94, v62, v94
  v_lshlrev_b32 v62, 16, v94
  v_and_b32 v94, s38, v94
  v_mul_f32 v62, v62, v8
  v_mul_f32 v94, v94, v8
  v_cvt_pk_bf16_f32 v29, v62, v94
  v_sub_f32 v59, v59, v7
  v_sub_f32 v91, v91, v7
  v_cvt_pk_bf16_f32 v91, v59, v91
  v_lshlrev_b32 v59, 16, v91
  v_and_b32 v91, s38, v91
  v_mul_f32 v59, v59, v8
  v_mul_f32 v91, v91, v8
  v_cvt_pk_bf16_f32 v30, v59, v91
  v_sub_f32 v63, v63, v7
  v_sub_f32 v95, v95, v7
  v_cvt_pk_bf16_f32 v95, v63, v95
  v_lshlrev_b32 v63, 16, v95
  v_and_b32 v95, s38, v95
  v_mul_f32 v63, v63, v8
  v_mul_f32 v95, v95, v8
  v_cvt_pk_bf16_f32 v31, v63, v95
  buffer_store_dwordx4 v[28:31], v5, s[8:11], s39 offen offset:768 sc1
  v_sub_f32 v64, v64, v7
  v_sub_f32 v96, v96, v7
  v_cvt_pk_bf16_f32 v96, v64, v96
  v_lshlrev_b32 v64, 16, v96
  v_and_b32 v96, s38, v96
  v_mul_f32 v64, v64, v8
  v_mul_f32 v96, v96, v8
  v_cvt_pk_bf16_f32 v32, v64, v96
  v_sub_f32 v68, v68, v7
  v_sub_f32 v100, v100, v7
  v_cvt_pk_bf16_f32 v100, v68, v100
  v_lshlrev_b32 v68, 16, v100
  v_and_b32 v100, s38, v100
  v_mul_f32 v68, v68, v8
  v_mul_f32 v100, v100, v8
  v_cvt_pk_bf16_f32 v33, v68, v100
  v_sub_f32 v65, v65, v7
  v_sub_f32 v97, v97, v7
  v_cvt_pk_bf16_f32 v97, v65, v97
  v_lshlrev_b32 v65, 16, v97
  v_and_b32 v97, s38, v97
  v_mul_f32 v65, v65, v8
  v_mul_f32 v97, v97, v8
  v_cvt_pk_bf16_f32 v34, v65, v97
  v_sub_f32 v69, v69, v7
  v_sub_f32 v101, v101, v7
  v_cvt_pk_bf16_f32 v101, v69, v101
  v_lshlrev_b32 v69, 16, v101
  v_and_b32 v101, s38, v101
  v_mul_f32 v69, v69, v8
  v_mul_f32 v101, v101, v8
  v_cvt_pk_bf16_f32 v35, v69, v101
  buffer_store_dwordx4 v[32:35], v5, s[8:11], s39 offen offset:1024 sc1
  v_sub_f32 v66, v66, v7
  v_sub_f32 v98, v98, v7
  v_cvt_pk_bf16_f32 v98, v66, v98
  v_lshlrev_b32 v66, 16, v98
  v_and_b32 v98, s38, v98
  v_mul_f32 v66, v66, v8
  v_mul_f32 v98, v98, v8
  v_cvt_pk_bf16_f32 v36, v66, v98
  v_sub_f32 v70, v70, v7
  v_sub_f32 v102, v102, v7
  v_cvt_pk_bf16_f32 v102, v70, v102
  v_lshlrev_b32 v70, 16, v102
  v_and_b32 v102, s38, v102
  v_mul_f32 v70, v70, v8
  v_mul_f32 v102, v102, v8
  v_cvt_pk_bf16_f32 v37, v70, v102
  v_sub_f32 v67, v67, v7
  v_sub_f32 v99, v99, v7
  v_cvt_pk_bf16_f32 v99, v67, v99
  v_lshlrev_b32 v67, 16, v99
  v_and_b32 v99, s38, v99
  v_mul_f32 v67, v67, v8
  v_mul_f32 v99, v99, v8
  v_cvt_pk_bf16_f32 v38, v67, v99
  v_sub_f32 v71, v71, v7
  v_sub_f32 v103, v103, v7
  v_cvt_pk_bf16_f32 v103, v71, v103
  v_lshlrev_b32 v71, 16, v103
  v_and_b32 v103, s38, v103
  v_mul_f32 v71, v71, v8
  v_mul_f32 v103, v103, v8
  v_cvt_pk_bf16_f32 v39, v71, v103
  buffer_store_dwordx4 v[36:39], v5, s[8:11], s39 offen offset:1280 sc1
  v_sub_f32 v72, v72, v7
  v_sub_f32 v104, v104, v7
  v_cvt_pk_bf16_f32 v104, v72, v104
  v_lshlrev_b32 v72, 16, v104
  v_and_b32 v104, s38, v104
  v_mul_f32 v72, v72, v8
  v_mul_f32 v104, v104, v8
  v_cvt_pk_bf16_f32 v40, v72, v104
  v_sub_f32 v76, v76, v7
  v_sub_f32 v108, v108, v7
  v_cvt_pk_bf16_f32 v108, v76, v108
  v_lshlrev_b32 v76, 16, v108
  v_and_b32 v108, s38, v108
  v_mul_f32 v76, v76, v8
  v_mul_f32 v108, v108, v8
  v_cvt_pk_bf16_f32 v41, v76, v108
  v_sub_f32 v73, v73, v7
  v_sub_f32 v105, v105, v7
  v_cvt_pk_bf16_f32 v105, v73, v105
  v_lshlrev_b32 v73, 16, v105
  v_and_b32 v105, s38, v105
  v_mul_f32 v73, v73, v8
  v_mul_f32 v105, v105, v8
  v_cvt_pk_bf16_f32 v42, v73, v105
  v_sub_f32 v77, v77, v7
  v_sub_f32 v109, v109, v7
  v_cvt_pk_bf16_f32 v109, v77, v109
  v_lshlrev_b32 v77, 16, v109
  v_and_b32 v109, s38, v109
  v_mul_f32 v77, v77, v8
  v_mul_f32 v109, v109, v8
  v_cvt_pk_bf16_f32 v43, v77, v109
  buffer_store_dwordx4 v[40:43], v5, s[8:11], s39 offen offset:1536 sc1
  v_sub_f32 v74, v74, v7
  v_sub_f32 v106, v106, v7
  v_cvt_pk_bf16_f32 v106, v74, v106
  v_lshlrev_b32 v74, 16, v106
  v_and_b32 v106, s38, v106
  v_mul_f32 v74, v74, v8
  v_mul_f32 v106, v106, v8
  v_cvt_pk_bf16_f32 v44, v74, v106
  v_sub_f32 v78, v78, v7
  v_sub_f32 v110, v110, v7
  v_cvt_pk_bf16_f32 v110, v78, v110
  v_lshlrev_b32 v78, 16, v110
  v_and_b32 v110, s38, v110
  v_mul_f32 v78, v78, v8
  v_mul_f32 v110, v110, v8
  v_cvt_pk_bf16_f32 v45, v78, v110
  v_sub_f32 v75, v75, v7
  v_sub_f32 v107, v107, v7
  v_cvt_pk_bf16_f32 v107, v75, v107
  v_lshlrev_b32 v75, 16, v107
  v_and_b32 v107, s38, v107
  v_mul_f32 v75, v75, v8
  v_mul_f32 v107, v107, v8
  v_cvt_pk_bf16_f32 v46, v75, v107
  v_sub_f32 v79, v79, v7
  v_sub_f32 v111, v111, v7
  v_cvt_pk_bf16_f32 v111, v79, v111
  v_lshlrev_b32 v79, 16, v111
  v_and_b32 v111, s38, v111
  v_mul_f32 v79, v79, v8
  v_mul_f32 v111, v111, v8
  v_cvt_pk_bf16_f32 v47, v79, v111
  buffer_store_dwordx4 v[44:47], v5, s[8:11], s39 offen offset:1792 sc1
  s_add_u32 s90, s90, 1
  s_bitcmp1_b32 s90, 0
  s_cbranch_scc1 ln_top
  s_waitcnt vmcnt(0)
  s_barrier
  s_cmp_lg_u32 s32, 0
  s_cbranch_scc1 ln_done
  s_mov_b64 exec, 1
  v_mov_b32 v8, 2
  v_mov_b32 v9, 192
  buffer_atomic_add v8, v9, s[12:15], 0 offen sc1
  s_mov_b64 exec, -1
ln_done:
  s_mov_b32 s36, s33
  s_load_dwordx4 s[16:19], s[0:1], 16
  s_load_dwordx4 s[24:27], s[0:1], 32
  s_lshl_b32 s36, s36, 2
  s_add_u32 s36, s36, s32
  s_lshl_b32 s36, s36, 10
  s_waitcnt lgkmcnt(0)
  s_mov_b32 s20, s18
  s_and_b32 s21, s19, 0xffff
  s_mov_b32 s22, 0x400000
  s_mov_b32 s23, 0x20000
  s_and_b32 s17, s17, 0xffff
  s_mov_b32 s18, 0x400000
  s_mov_b32 s19, 0x20000
  s_mov_b32 s28, s26
  s_and_b32 s29, s27, 0xffff
  s_mov_b32 s30, 0x400000
  s_mov_b32 s31, 0x20000
  s_and_b32 s25, s25, 0xffff
  s_mov_b32 s26, 0x400000
  s_mov_b32 s27, 0x20000
  s_add_u32 s37, s36, 1048576
  buffer_load_dwordx4 v[112:115], v0, s[8:11], s37 offen
  s_add_u32 s37, s36, 1179648
  buffer_load_dwordx4 v[112:115], v0, s[8:11], s37 offen
  s_add_u32 s37, s36, 1310720
  buffer_load_dwordx4 v[112:115], v0, s[8:11], s37 offen
  s_add_u32 s37, s36, 1441792
  buffer_load_dwordx4 v[112:115], v0, s[8:11], s37 offen
  s_add_u32 s37, s36, 1572864
  buffer_load_dwordx4 v[112:115], v0, s[8:11], s37 offen
  s_add_u32 s37, s36, 1703936
  buffer_load_dwordx4 v[112:115], v0, s[8:11], s37 offen
  s_add_u32 s37, s36, 1835008
  buffer_load_dwordx4 v[112:115], v0, s[8:11], s37 offen
  s_add_u32 s37, s36, 1966080
  buffer_load_dwordx4 v[112:115], v0, s[8:11], s37 offen
  s_and_b32 s37, s36, 0x7c00
  s_add_u32 s37, s37, 458752
  buffer_load_dwordx4 v[112:115], v0, s[8:11], s37 offen
  s_load_dwordx4 s[16:19], s[0:1], 64
  s_load_dwordx2 s[24:25], s[0:1], 80
  s_waitcnt lgkmcnt(0)
  s_mov_b32 s20, s18
  s_and_b32 s21, s19, 0xffff
  s_mov_b32 s22, 1409024
  s_and_b32 s17, s17, 0xffff
  s_mov_b32 s18, 1409024
  s_mov_b32 s19, 0x20000
  s_and_b32 s25, s25, 0xffff
  s_mov_b32 s26, 1409024
  s_add_u32 s37, s36, 0
  buffer_load_dwordx4 v[112:115], v0, s[16:19], s37 offen
  s_waitcnt vmcnt(10)
  s_add_u32 s37, s36, 131072
  buffer_load_dwordx4 v[116:119], v0, s[16:19], s37 offen
  s_waitcnt vmcnt(10)
  s_add_u32 s37, s36, 262144
  buffer_load_dwordx4 v[120:123], v0, s[16:19], s37 offen
  s_waitcnt vmcnt(10)
  s_add_u32 s37, s36, 393216
  buffer_load_dwordx4 v[124:127], v0, s[16:19], s37 offen
  s_waitcnt vmcnt(10)
  s_add_u32 s37, s36, 524288
  buffer_load_dwordx4 v[112:115], v0, s[16:19], s37 offen
  s_waitcnt vmcnt(10)
  s_add_u32 s37, s36, 655360
  buffer_load_dwordx4 v[116:119], v0, s[16:19], s37 offen
  s_waitcnt vmcnt(10)
  s_add_u32 s37, s36, 786432
  buffer_load_dwordx4 v[120:123], v0, s[16:19], s37 offen
  s_waitcnt vmcnt(10)
  s_add_u32 s37, s36, 917504
  buffer_load_dwordx4 v[124:127], v0, s[16:19], s37 offen
  s_waitcnt vmcnt(10)
  s_add_u32 s37, s36, 1048576
  buffer_load_dwordx4 v[112:115], v0, s[16:19], s37 offen
  s_waitcnt vmcnt(10)
  s_add_u32 s37, s36, 1179648
  buffer_load_dwordx4 v[116:119], v0, s[16:19], s37 offen
  s_waitcnt vmcnt(10)
  s_add_u32 s37, s36, 1310720
  buffer_load_dwordx4 v[120:123], v0, s[16:19], s37 offen
  s_waitcnt vmcnt(10)
  s_add_u32 s37, s36, 0
  buffer_load_dwordx4 v[124:127], v0, s[20:23], s37 offen
  s_waitcnt vmcnt(10)
  s_add_u32 s37, s36, 131072
  buffer_load_dwordx4 v[112:115], v0, s[20:23], s37 offen
  s_waitcnt vmcnt(10)
  s_add_u32 s37, s36, 262144
  buffer_load_dwordx4 v[116:119], v0, s[20:23], s37 offen
  s_waitcnt vmcnt(10)
  s_add_u32 s37, s36, 393216
  buffer_load_dwordx4 v[120:123], v0, s[20:23], s37 offen
  s_waitcnt vmcnt(10)
  s_add_u32 s37, s36, 524288
  buffer_load_dwordx4 v[124:127], v0, s[20:23], s37 offen
  s_waitcnt vmcnt(10)
  s_add_u32 s37, s36, 655360
  buffer_load_dwordx4 v[112:115], v0, s[20:23], s37 offen
  s_waitcnt vmcnt(10)
  s_add_u32 s37, s36, 786432
  buffer_load_dwordx4 v[116:119], v0, s[20:23], s37 offen
  s_waitcnt vmcnt(10)
  s_add_u32 s37, s36, 917504
  buffer_load_dwordx4 v[120:123], v0, s[20:23], s37 offen
  s_waitcnt vmcnt(10)
  s_add_u32 s37, s36, 1048576
  buffer_load_dwordx4 v[124:127], v0, s[20:23], s37 offen
  s_waitcnt vmcnt(10)
  s_add_u32 s37, s36, 1179648
  buffer_load_dwordx4 v[112:115], v0, s[20:23], s37 offen
  s_waitcnt vmcnt(10)
  s_add_u32 s37, s36, 1310720
  buffer_load_dwordx4 v[116:119], v0, s[20:23], s37 offen
  s_waitcnt vmcnt(10)
  s_add_u32 s37, s36, 0
  buffer_load_dwordx4 v[120:123], v0, s[24:27], s37 offen
  s_waitcnt vmcnt(10)
  s_add_u32 s37, s36, 131072
  buffer_load_dwordx4 v[124:127], v0, s[24:27], s37 offen
  s_waitcnt vmcnt(10)
  s_add_u32 s37, s36, 262144
  buffer_load_dwordx4 v[112:115], v0, s[24:27], s37 offen
  s_waitcnt vmcnt(10)
  s_add_u32 s37, s36, 393216
  buffer_load_dwordx4 v[116:119], v0, s[24:27], s37 offen
  s_waitcnt vmcnt(10)
  s_add_u32 s37, s36, 524288
  buffer_load_dwordx4 v[120:123], v0, s[24:27], s37 offen
  s_waitcnt vmcnt(10)
  s_add_u32 s37, s36, 655360
  buffer_load_dwordx4 v[124:127], v0, s[24:27], s37 offen
  s_waitcnt vmcnt(10)
  s_add_u32 s37, s36, 786432
  buffer_load_dwordx4 v[112:115], v0, s[24:27], s37 offen
  s_waitcnt vmcnt(10)
  s_add_u32 s37, s36, 917504
  buffer_load_dwordx4 v[116:119], v0, s[24:27], s37 offen
  s_waitcnt vmcnt(10)
  s_add_u32 s37, s36, 1048576
  buffer_load_dwordx4 v[120:123], v0, s[24:27], s37 offen
  s_waitcnt vmcnt(10)
  s_add_u32 s37, s36, 1179648
  buffer_load_dwordx4 v[124:127], v0, s[24:27], s37 offen
  s_waitcnt vmcnt(10)
  s_add_u32 s37, s36, 1310720
  buffer_load_dwordx4 v[112:115], v0, s[24:27], s37 offen
  s_waitcnt vmcnt(10)
  s_endpgm
L_w2:
  s_sub_u32 s88, s3, 2
  s_lshl_b32 s88, s88, 5
  s_add_u32 s88, s88, s33
  s_mul_i32 s33, s88, 10923
  s_lshr_b32 s33, s33, 16
  s_mul_i32 s36, s33, 6
  s_sub_u32 s89, s88, s36
  s_mov_b32 s40, s89
  s_cmp_lt_u32 s89, 3
  s_cbranch_scc1 L_noln
  s_add_u32 s40, s89, 3
  s_mul_i32 s36, s33, 3
  s_add_u32 s36, s36, s89
  s_sub_u32 s36, s36, 3
  s_load_dwordx4 s[16:19], s[0:1], 16
  s_load_dwordx4 s[24:27], s[0:1], 32
  s_lshl_b32 s36, s36, 2
  s_add_u32 s36, s36, s32
  s_lshl_b32 s36, s36, 10
  s_waitcnt lgkmcnt(0)
  s_mov_b32 s20, s18
  s_and_b32 s21, s19, 0xffff
  s_mov_b32 s22, 0x400000
  s_mov_b32 s23, 0x20000
  s_and_b32 s17, s17, 0xffff
  s_mov_b32 s18, 0x400000
  s_mov_b32 s19, 0x20000
  s_mov_b32 s28, s26
  s_and_b32 s29, s27, 0xffff
  s_mov_b32 s30, 0x400000
  s_mov_b32 s31, 0x20000
  s_and_b32 s25, s25, 0xffff
  s_mov_b32 s26, 0x400000
  s_mov_b32 s27, 0x20000
  s_add_u32 s37, s36, 0
  buffer_load_dwordx4 v[112:115], v0, s[20:23], s37 offen
  s_waitcnt vmcnt(6)
  s_add_u32 s37, s36, 393216
  buffer_load_dwordx4 v[116:119], v0, s[20:23], s37 offen
  s_waitcnt vmcnt(6)
  s_add_u32 s37, s36, 786432
  buffer_load_dwordx4 v[120:123], v0, s[20:23], s37 offen
  s_waitcnt vmcnt(6)
  s_add_u32 s37, s36, 1179648
  buffer_load_dwordx4 v[124:127], v0, s[20:23], s37 offen
  s_waitcnt vmcnt(6)
  s_add_u32 s37, s36, 1572864
  buffer_load_dwordx4 v[112:115], v0, s[20:23], s37 offen
  s_waitcnt vmcnt(6)
  s_add_u32 s37, s36, 1966080
  buffer_load_dwordx4 v[116:119], v0, s[20:23], s37 offen
  s_waitcnt vmcnt(6)
  s_add_u32 s37, s36, 2359296
  buffer_load_dwordx4 v[120:123], v0, s[20:23], s37 offen
  s_waitcnt vmcnt(6)
  s_add_u32 s37, s36, 2752512
  buffer_load_dwordx4 v[124:127], v0, s[20:23], s37 offen
  s_waitcnt vmcnt(6)
  s_add_u32 s37, s36, 3145728
  buffer_load_dwordx4 v[112:115], v0, s[20:23], s37 offen
  s_waitcnt vmcnt(6)
  s_add_u32 s37, s36, 3538944
  buffer_load_dwordx4 v[116:119], v0, s[20:23], s37 offen
  s_waitcnt vmcnt(6)
  s_add_u32 s37, s36, 3932160
  buffer_load_dwordx4 v[120:123], v0, s[20:23], s37 offen
  s_waitcnt vmcnt(6)
  s_add_u32 s37, s36, 0
  buffer_load_dwordx4 v[124:127], v0, s[24:27], s37 offen
  s_waitcnt vmcnt(6)
  s_add_u32 s37, s36, 393216
  buffer_load_dwordx4 v[112:115], v0, s[24:27], s37 offen
  s_waitcnt vmcnt(6)
  s_add_u32 s37, s36, 786432
  buffer_load_dwordx4 v[116:119], v0, s[24:27], s37 offen
  s_waitcnt vmcnt(6)
  s_add_u32 s37, s36, 1179648
  buffer_load_dwordx4 v[120:123], v0, s[24:27], s37 offen
  s_waitcnt vmcnt(6)
  s_add_u32 s37, s36, 1572864
  buffer_load_dwordx4 v[124:127], v0, s[24:27], s37 offen
  s_waitcnt vmcnt(6)
  s_add_u32 s37, s36, 1966080
  buffer_load_dwordx4 v[112:115], v0, s[24:27], s37 offen
  s_waitcnt vmcnt(6)
  s_add_u32 s37, s36, 2359296
  buffer_load_dwordx4 v[116:119], v0, s[24:27], s37 offen
  s_waitcnt vmcnt(6)
  s_add_u32 s37, s36, 2752512
  buffer_load_dwordx4 v[120:123], v0, s[24:27], s37 offen
  s_waitcnt vmcnt(6)
  s_add_u32 s37, s36, 3145728
  buffer_load_dwordx4 v[124:127], v0, s[24:27], s37 offen
  s_waitcnt vmcnt(6)
  s_add_u32 s37, s36, 3538944
  buffer_load_dwordx4 v[112:115], v0, s[24:27], s37 offen
  s_waitcnt vmcnt(6)
  s_add_u32 s37, s36, 3932160
  buffer_load_dwordx4 v[116:119], v0, s[24:27], s37 offen
  s_waitcnt vmcnt(6)
  s_add_u32 s37, s36, 0
  buffer_load_dwordx4 v[120:123], v0, s[16:19], s37 offen
  s_waitcnt vmcnt(6)
  s_add_u32 s37, s36, 393216
  buffer_load_dwordx4 v[124:127], v0, s[16:19], s37 offen
  s_waitcnt vmcnt(6)
  s_add_u32 s37, s36, 786432
  buffer_load_dwordx4 v[112:115], v0, s[16:19], s37 offen
  s_waitcnt vmcnt(6)
  s_add_u32 s37, s36, 1179648
  buffer_load_dwordx4 v[116:119], v0, s[16:19], s37 offen
  s_waitcnt vmcnt(6)
  s_add_u32 s37, s36, 1572864
  buffer_load_dwordx4 v[120:123], v0, s[16:19], s37 offen
  s_waitcnt vmcnt(6)
  s_add_u32 s37, s36, 1966080
  buffer_load_dwordx4 v[124:127], v0, s[16:19], s37 offen
  s_waitcnt vmcnt(6)
  s_add_u32 s37, s36, 2359296
  buffer_load_dwordx4 v[112:115], v0, s[16:19], s37 offen
  s_waitcnt vmcnt(6)
  s_add_u32 s37, s36, 2752512
  buffer_load_dwordx4 v[116:119], v0, s[16:19], s37 offen
  s_waitcnt vmcnt(6)
  s_add_u32 s37, s36, 3145728
  buffer_load_dwordx4 v[120:123], v0, s[16:19], s37 offen
  s_waitcnt vmcnt(6)
  s_add_u32 s37, s36, 3538944
  buffer_load_dwordx4 v[124:127], v0, s[16:19], s37 offen
  s_waitcnt vmcnt(6)
  s_add_u32 s37, s36, 3932160
  buffer_load_dwordx4 v[112:115], v0, s[16:19], s37 offen
  s_waitcnt vmcnt(6)
  s_add_u32 s37, s36, 0
  buffer_load_dwordx4 v[116:119], v0, s[28:31], s37 offen
  s_waitcnt vmcnt(6)
  s_add_u32 s37, s36, 393216
  buffer_load_dwordx4 v[120:123], v0, s[28:31], s37 offen
  s_waitcnt vmcnt(6)
  s_add_u32 s37, s36, 786432
  buffer_load_dwordx4 v[124:127], v0, s[28:31], s37 offen
  s_waitcnt vmcnt(6)
  s_add_u32 s37, s36, 1179648
  buffer_load_dwordx4 v[112:115], v0, s[28:31], s37 offen
  s_waitcnt vmcnt(6)
  s_add_u32 s37, s36, 1572864
  buffer_load_dwordx4 v[116:119], v0, s[28:31], s37 offen
  s_waitcnt vmcnt(6)
  s_add_u32 s37, s36, 1966080
  buffer_load_dwordx4 v[120:123], v0, s[28:31], s37 offen
  s_waitcnt vmcnt(6)
  s_add_u32 s37, s36, 2359296
  buffer_load_dwordx4 v[124:127], v0, s[28:31], s37 offen
  s_waitcnt vmcnt(6)
  s_add_u32 s37, s36, 2752512
  buffer_load_dwordx4 v[112:115], v0, s[28:31], s37 offen
  s_waitcnt vmcnt(6)
  s_add_u32 s37, s36, 3145728
  buffer_load_dwordx4 v[116:119], v0, s[28:31], s37 offen
  s_waitcnt vmcnt(6)
  s_add_u32 s37, s36, 3538944
  buffer_load_dwordx4 v[120:123], v0, s[28:31], s37 offen
  s_waitcnt vmcnt(6)
  s_add_u32 s37, s36, 3932160
  buffer_load_dwordx4 v[124:127], v0, s[28:31], s37 offen
  s_waitcnt vmcnt(6)
L_noln:
  s_load_dwordx4 s[16:19], s[0:1], 16
  s_load_dwordx2 s[24:25], s[0:1], 32
  s_waitcnt lgkmcnt(0)
  s_mov_b32 s20, s18
  s_and_b32 s21, s19, 0xffff
  s_mov_b32 s22, 0x400000
  s_mov_b32 s23, 0x20000
  s_and_b32 s17, s17, 0xffff
  s_mov_b32 s18, 0x400000
  s_mov_b32 s19, 0x20000
  s_and_b32 s25, s25, 0xffff
  s_mov_b32 s26, 0x400000
  s_mov_b32 s27, 0x20000
  s_lshl_b32 s45, s33, 8
  s_lshl_b32 s37, s32, 6
  s_and_b32 s37, s37, 0x80
  s_add_u32 s45, s45, s37
  s_and_b32 s37, s32, 1
  s_lshl_b32 s37, s37, 17
  s_add_u32 s45, s45, s37
  v_bfe_u32 v21, v1, 4, 1
  v_bfe_u32 v22, v1, 3, 1
  v_bfe_u32 v23, v1, 2, 1
  v_bfe_u32 v24, v1, 1, 1
  v_and_b32 v25, 1, v1
  v_lshrrev_b32 v26, 5, v1
  v_lshlrev_b32 v27, 1, v26
  v_lshl_add_u32 v27, v21, 2, v27
  v_lshl_add_u32 v27, v22, 5, v27
  v_mul_u32_u24 v27, 8192, v27
  v_bfe_u32 v28, v1, 4, 2
  v_lshlrev_b32 v28, 1, v28
  v_and_b32 v29, 7, v1
  v_xor_b32 v28, v28, v29
  v_lshl_add_u32 v3, v28, 4, v27
  v_lshlrev_b32 v27, 10, v26
  v_bfe_u32 v28, v1, 2, 3
  v_lshl_add_u32 v27, v28, 7, v27
  v_and_b32 v28, 3, v1
  v_lshl_add_u32 v27, v28, 3, v27
  v_bfe_u32 v28, v1, 3, 2
  s_lshl_b32 s38, s32, 1
  s_and_b32 s38, s38, 2
  v_xor_b32 v28, s38, v28
  v_lshl_add_u32 v29, v28, 5, v27
  v_xor_b32 v28, 1, v28
  v_lshl_add_u32 v30, v28, 5, v27
  s_and_b32 s38, s32, 2
  s_mul_i32 s38, s38, 40960
  s_add_u32 s39, s38, 40960
  v_add_u32 v100, s38, v29
  v_add_u32 v101, s38, v30
  v_add_u32 v102, s39, v29
  v_add_u32 v103, s39, v30
  s_add_u32 m0, s52, 0
  s_add_u32 s38, s45, 0
  buffer_load_dwordx4 v3, s[20:23], s38 offen lds
  s_add_u32 m0, s52, 1024
  s_add_u32 s38, s45, 65536
  buffer_load_dwordx4 v3, s[20:23], s38 offen lds
  s_add_u32 m0, s52, 2048
  s_add_u32 s38, s45, 8192
  buffer_load_dwordx4 v3, s[20:23], s38 offen lds
  s_add_u32 m0, s52, 3072
  s_add_u32 s38, s45, 73728
  buffer_load_dwordx4 v3, s[20:23], s38 offen lds
  s_add_u32 m0, s52, 4096
  s_add_u32 s38, s45, 524288
  buffer_load_dwordx4 v3, s[20:23], s38 offen lds
  s_add_u32 m0, s52, 5120
  s_add_u32 s38, s45, 589824
  buffer_load_dwordx4 v3, s[20:23], s38 offen lds
  s_add_u32 m0, s52, 6144
  s_add_u32 s38, s45, 532480
  buffer_load_dwordx4 v3, s[20:23], s38 offen lds
  s_add_u32 m0, s52, 7168
  s_add_u32 s38, s45, 598016
  buffer_load_dwordx4 v3, s[20:23], s38 offen lds
  s_add_u32 m0, s52, 8192
  s_add_u32 s38, s45, 1048576
  buffer_load_dwordx4 v3, s[20:23], s38 offen lds
  s_add_u32 m0, s52, 9216
  s_add_u32 s38, s45, 1114112
  buffer_load_dwordx4 v3, s[20:23], s38 offen lds
  s_add_u32 m0, s52, 10240
  s_add_u32 s38, s45, 1056768
  buffer_load_dwordx4 v3, s[20:23], s38 offen lds
  s_add_u32 m0, s52, 11264
  s_add_u32 s38, s45, 1122304
  buffer_load_dwordx4 v3, s[20:23], s38 offen lds
  s_add_u32 m0, s52, 12288
  s_add_u32 s38, s45, 1572864
  buffer_load_dwordx4 v3, s[20:23], s38 offen lds
  s_add_u32 m0, s52, 13312
  s_add_u32 s38, s45, 1638400
  buffer_load_dwordx4 v3, s[20:23], s38 offen lds
  s_add_u32 m0, s52, 14336
  s_add_u32 s38, s45, 1581056
  buffer_load_dwordx4 v3, s[20:23], s38 offen lds
  s_add_u32 m0, s52, 15360
  s_add_u32 s38, s45, 1646592
  buffer_load_dwordx4 v3, s[20:23], s38 offen lds
  s_add_u32 m0, s52, 16384
  s_add_u32 s38, s45, 2097152
  buffer_load_dwordx4 v3, s[20:23], s38 offen lds
  s_add_u32 m0, s52, 17408
  s_add_u32 s38, s45, 2162688
  buffer_load_dwordx4 v3, s[20:23], s38 offen lds
  s_add_u32 m0, s52, 18432
  s_add_u32 s38, s45, 2105344
  buffer_load_dwordx4 v3, s[20:23], s38 offen lds
  s_add_u32 m0, s52, 19456
  s_add_u32 s38, s45, 2170880
  buffer_load_dwordx4 v3, s[20:23], s38 offen lds
  s_add_u32 m0, s52, 20480
  s_add_u32 s38, s45, 2621440
  buffer_load_dwordx4 v3, s[20:23], s38 offen lds
  s_add_u32 m0, s52, 21504
  s_add_u32 s38, s45, 2686976
  buffer_load_dwordx4 v3, s[20:23], s38 offen lds
  s_add_u32 m0, s52, 22528
  s_add_u32 s38, s45, 2629632
  buffer_load_dwordx4 v3, s[20:23], s38 offen lds
  s_add_u32 m0, s52, 23552
  s_add_u32 s38, s45, 2695168
  buffer_load_dwordx4 v3, s[20:23], s38 offen lds
  s_add_u32 m0, s52, 24576
  s_add_u32 s38, s45, 3145728
  buffer_load_dwordx4 v3, s[20:23], s38 offen lds
  s_add_u32 m0, s52, 25600
  s_add_u32 s38, s45, 3211264
  buffer_load_dwordx4 v3, s[20:23], s38 offen lds
  s_add_u32 m0, s52, 26624
  s_add_u32 s38, s45, 3153920
  buffer_load_dwordx4 v3, s[20:23], s38 offen lds
  s_add_u32 m0, s52, 27648
  s_add_u32 s38, s45, 3219456
  buffer_load_dwordx4 v3, s[20:23], s38 offen lds
  s_add_u32 m0, s52, 28672
  s_add_u32 s38, s45, 3670016
  buffer_load_dwordx4 v3, s[20:23], s38 offen lds
  s_add_u32 m0, s52, 29696
  s_add_u32 s38, s45, 3735552
  buffer_load_dwordx4 v3, s[20:23], s38 offen lds
  s_add_u32 m0, s52, 30720
  s_add_u32 s38, s45, 3678208
  buffer_load_dwordx4 v3, s[20:23], s38 offen lds
  s_add_u32 m0, s52, 31744
  s_add_u32 s38, s45, 3743744
  buffer_load_dwordx4 v3, s[20:23], s38 offen lds
  s_waitcnt vmcnt(28) lgkmcnt(0)
  s_barrier
  s_add_u32 m0, s52, 32768
  s_add_u32 s38, s45, 0
  buffer_load_dwordx4 v3, s[24:27], s38 offen lds
  s_add_u32 m0, s52, 33792
  s_add_u32 s38, s45, 65536
  buffer_load_dwordx4 v3, s[24:27], s38 offen lds
  s_add_u32 m0, s52, 34816
  s_add_u32 s38, s45, 8192
  buffer_load_dwordx4 v3, s[24:27], s38 offen lds
  s_add_u32 m0, s52, 35840
  s_add_u32 s38, s45, 73728
  buffer_load_dwordx4 v3, s[24:27], s38 offen lds
  ds_read_b64_tr_b16 a[0:1], v100 offset:0
  ds_read_b64_tr_b16 a[2:3], v100 offset:2048
  ds_read_b64_tr_b16 a[4:5], v102 offset:0
  ds_read_b64_tr_b16 a[6:7], v102 offset:2048
  ds_read_b64_tr_b16 a[8:9], v101 offset:0
  ds_read_b64_tr_b16 a[10:11], v101 offset:2048
  ds_read_b64_tr_b16 a[12:13], v103 offset:0
  ds_read_b64_tr_b16 a[14:15], v103 offset:2048
  s_waitcnt vmcnt(28) lgkmcnt(0)
  s_barrier
  s_add_u32 m0, s52, 0
  s_add_u32 s38, s45, 524288
  buffer_load_dwordx4 v3, s[24:27], s38 offen lds
  s_add_u32 m0, s52, 1024
  s_add_u32 s38, s45, 589824
  buffer_load_dwordx4 v3, s[24:27], s38 offen lds
  s_add_u32 m0, s52, 2048
  s_add_u32 s38, s45, 532480
  buffer_load_dwordx4 v3, s[24:27], s38 offen lds
  s_add_u32 m0, s52, 3072
  s_add_u32 s38, s45, 598016
  buffer_load_dwordx4 v3, s[24:27], s38 offen lds
  ds_read_b64_tr_b16 a[16:17], v100 offset:4096
  ds_read_b64_tr_b16 a[18:19], v100 offset:6144
  ds_read_b64_tr_b16 a[20:21], v102 offset:4096
  ds_read_b64_tr_b16 a[22:23], v102 offset:6144
  ds_read_b64_tr_b16 a[24:25], v101 offset:4096
  ds_read_b64_tr_b16 a[26:27], v101 offset:6144
  ds_read_b64_tr_b16 a[28:29], v103 offset:4096
  ds_read_b64_tr_b16 a[30:31], v103 offset:6144
  s_waitcnt vmcnt(28) lgkmcnt(0)
  s_barrier
  s_add_u32 m0, s52, 4096
  s_add_u32 s38, s45, 1048576
  buffer_load_dwordx4 v3, s[24:27], s38 offen lds
  s_add_u32 m0, s52, 5120
  s_add_u32 s38, s45, 1114112
  buffer_load_dwordx4 v3, s[24:27], s38 offen lds
  s_add_u32 m0, s52, 6144
  s_add_u32 s38, s45, 1056768
  buffer_load_dwordx4 v3, s[24:27], s38 offen lds
  s_add_u32 m0, s52, 7168
  s_add_u32 s38, s45, 1122304
  buffer_load_dwordx4 v3, s[24:27], s38 offen lds
  ds_read_b64_tr_b16 a[32:33], v100 offset:8192
  ds_read_b64_tr_b16 a[34:35], v100 offset:10240
  ds_read_b64_tr_b16 a[36:37], v102 offset:8192
  ds_read_b64_tr_b16 a[38:39], v102 offset:10240
  ds_read_b64_tr_b16 a[40:41], v101 offset:8192
  ds_read_b64_tr_b16 a[42:43], v101 offset:10240
  ds_read_b64_tr_b16 a[44:45], v103 offset:8192
  ds_read_b64_tr_b16 a[46:47], v103 offset:10240
  s_waitcnt vmcnt(28) lgkmcnt(0)
  s_barrier
  s_add_u32 m0, s52, 8192
  s_add_u32 s38, s45, 1572864
  buffer_load_dwordx4 v3, s[24:27], s38 offen lds
  s_add_u32 m0, s52, 9216
  s_add_u32 s38, s45, 1638400
  buffer_load_dwordx4 v3, s[24:27], s38 offen lds
  s_add_u32 m0, s52, 10240
  s_add_u32 s38, s45, 1581056
  buffer_load_dwordx4 v3, s[24:27], s38 offen lds
  s_add_u32 m0, s52, 11264
  s_add_u32 s38, s45, 1646592
  buffer_load_dwordx4 v3, s[24:27], s38 offen lds
  ds_read_b64_tr_b16 a[48:49], v100 offset:12288
  ds_read_b64_tr_b16 a[50:51], v100 offset:14336
  ds_read_b64_tr_b16 a[52:53], v102 offset:12288
  ds_read_b64_tr_b16 a[54:55], v102 offset:14336
  ds_read_b64_tr_b16 a[56:57], v101 offset:12288
  ds_read_b64_tr_b16 a[58:59], v101 offset:14336
  ds_read_b64_tr_b16 a[60:61], v103 offset:12288
  ds_read_b64_tr_b16 a[62:63], v103 offset:14336
  s_waitcnt vmcnt(28) lgkmcnt(0)
  s_barrier
  s_add_u32 m0, s52, 12288
  s_add_u32 s38, s45, 2097152
  buffer_load_dwordx4 v3, s[24:27], s38 offen lds
  s_add_u32 m0, s52, 13312
  s_add_u32 s38, s45, 2162688
  buffer_load_dwordx4 v3, s[24:27], s38 offen lds
  s_add_u32 m0, s52, 14336
  s_add_u32 s38, s45, 2105344
  buffer_load_dwordx4 v3, s[24:27], s38 offen lds
  s_add_u32 m0, s52, 15360
  s_add_u32 s38, s45, 2170880
  buffer_load_dwordx4 v3, s[24:27], s38 offen lds
  ds_read_b64_tr_b16 a[64:65], v100 offset:16384
  ds_read_b64_tr_b16 a[66:67], v100 offset:18432
  ds_read_b64_tr_b16 a[68:69], v102 offset:16384
  ds_read_b64_tr_b16 a[70:71], v102 offset:18432
  ds_read_b64_tr_b16 a[72:73], v101 offset:16384
  ds_read_b64_tr_b16 a[74:75], v101 offset:18432
  ds_read_b64_tr_b16 a[76:77], v103 offset:16384
  ds_read_b64_tr_b16 a[78:79], v103 offset:18432
  s_waitcnt vmcnt(28) lgkmcnt(0)
  s_barrier
  s_add_u32 m0, s52, 16384
  s_add_u32 s38, s45, 2621440
  buffer_load_dwordx4 v3, s[24:27], s38 offen lds
  s_add_u32 m0, s52, 17408
  s_add_u32 s38, s45, 2686976
  buffer_load_dwordx4 v3, s[24:27], s38 offen lds
  s_add_u32 m0, s52, 18432
  s_add_u32 s38, s45, 2629632
  buffer_load_dwordx4 v3, s[24:27], s38 offen lds
  s_add_u32 m0, s52, 19456
  s_add_u32 s38, s45, 2695168
  buffer_load_dwordx4 v3, s[24:27], s38 offen lds
  ds_read_b64_tr_b16 a[80:81], v100 offset:20480
  ds_read_b64_tr_b16 a[82:83], v100 offset:22528
  ds_read_b64_tr_b16 a[84:85], v102 offset:20480
  ds_read_b64_tr_b16 a[86:87], v102 offset:22528
  ds_read_b64_tr_b16 a[88:89], v101 offset:20480
  ds_read_b64_tr_b16 a[90:91], v101 offset:22528
  ds_read_b64_tr_b16 a[92:93], v103 offset:20480
  ds_read_b64_tr_b16 a[94:95], v103 offset:22528
  s_waitcnt vmcnt(28) lgkmcnt(0)
  s_barrier
  s_add_u32 m0, s52, 20480
  s_add_u32 s38, s45, 3145728
  buffer_load_dwordx4 v3, s[24:27], s38 offen lds
  s_add_u32 m0, s52, 21504
  s_add_u32 s38, s45, 3211264
  buffer_load_dwordx4 v3, s[24:27], s38 offen lds
  s_add_u32 m0, s52, 22528
  s_add_u32 s38, s45, 3153920
  buffer_load_dwordx4 v3, s[24:27], s38 offen lds
  s_add_u32 m0, s52, 23552
  s_add_u32 s38, s45, 3219456
  buffer_load_dwordx4 v3, s[24:27], s38 offen lds
  ds_read_b64_tr_b16 a[96:97], v100 offset:24576
  ds_read_b64_tr_b16 a[98:99], v100 offset:26624
  ds_read_b64_tr_b16 a[100:101], v102 offset:24576
  ds_read_b64_tr_b16 a[102:103], v102 offset:26624
  ds_read_b64_tr_b16 a[104:105], v101 offset:24576
  ds_read_b64_tr_b16 a[106:107], v101 offset:26624
  ds_read_b64_tr_b16 a[108:109], v103 offset:24576
  ds_read_b64_tr_b16 a[110:111], v103 offset:26624
  s_waitcnt vmcnt(28) lgkmcnt(0)
  s_barrier
  s_add_u32 m0, s52, 24576
  s_add_u32 s38, s45, 3670016
  buffer_load_dwordx4 v3, s[24:27], s38 offen lds
  s_add_u32 m0, s52, 25600
  s_add_u32 s38, s45, 3735552
  buffer_load_dwordx4 v3, s[24:27], s38 offen lds
  s_add_u32 m0, s52, 26624
  s_add_u32 s38, s45, 3678208
  buffer_load_dwordx4 v3, s[24:27], s38 offen lds
  s_add_u32 m0, s52, 27648
  s_add_u32 s38, s45, 3743744
  buffer_load_dwordx4 v3, s[24:27], s38 offen lds
  ds_read_b64_tr_b16 a[112:113], v100 offset:28672
  ds_read_b64_tr_b16 a[114:115], v100 offset:30720
  ds_read_b64_tr_b16 a[116:117], v102 offset:28672
  ds_read_b64_tr_b16 a[118:119], v102 offset:30720
  ds_read_b64_tr_b16 a[120:121], v101 offset:28672
  ds_read_b64_tr_b16 a[122:123], v101 offset:30720
  ds_read_b64_tr_b16 a[124:125], v103 offset:28672
  ds_read_b64_tr_b16 a[126:127], v103 offset:30720
  s_waitcnt vmcnt(28) lgkmcnt(0)
  s_barrier
  s_add_u32 m0, s52, 28672
  s_add_u32 s38, s45, 0
  buffer_load_dwordx4 v3, s[16:19], s38 offen lds
  s_add_u32 m0, s52, 29696
  s_add_u32 s38, s45, 65536
  buffer_load_dwordx4 v3, s[16:19], s38 offen lds
  s_add_u32 m0, s52, 30720
  s_add_u32 s38, s45, 8192
  buffer_load_dwordx4 v3, s[16:19], s38 offen lds
  s_add_u32 m0, s52, 31744
  s_add_u32 s38, s45, 73728
  buffer_load_dwordx4 v3, s[16:19], s38 offen lds
  ds_read_b64_tr_b16 a[128:129], v100 offset:32768
  ds_read_b64_tr_b16 a[130:131], v100 offset:34816
  ds_read_b64_tr_b16 a[132:133], v102 offset:32768
  ds_read_b64_tr_b16 a[134:135], v102 offset:34816
  ds_read_b64_tr_b16 a[136:137], v101 offset:32768
  ds_read_b64_tr_b16 a[138:139], v101 offset:34816
  ds_read_b64_tr_b16 a[140:141], v103 offset:32768
  ds_read_b64_tr_b16 a[142:143], v103 offset:34816
  s_waitcnt vmcnt(28) lgkmcnt(0)
  s_barrier
  s_add_u32 m0, s52, 32768
  s_add_u32 s38, s45, 524288
  buffer_load_dwordx4 v3, s[16:19], s38 offen lds
  s_add_u32 m0, s52, 33792
  s_add_u32 s38, s45, 589824
  buffer_load_dwordx4 v3, s[16:19], s38 offen lds
  s_add_u32 m0, s52, 34816
  s_add_u32 s38, s45, 532480
  buffer_load_dwordx4 v3, s[16:19], s38 offen lds
  s_add_u32 m0, s52, 35840
  s_add_u32 s38, s45, 598016
  buffer_load_dwordx4 v3, s[16:19], s38 offen lds
  ds_read_b64_tr_b16 a[144:145], v100 offset:0
  ds_read_b64_tr_b16 a[146:147], v100 offset:2048
  ds_read_b64_tr_b16 a[148:149], v102 offset:0
  ds_read_b64_tr_b16 a[150:151], v102 offset:2048
  ds_read_b64_tr_b16 a[152:153], v101 offset:0
  ds_read_b64_tr_b16 a[154:155], v101 offset:2048
  ds_read_b64_tr_b16 a[156:157], v103 offset:0
  ds_read_b64_tr_b16 a[158:159], v103 offset:2048
  s_waitcnt vmcnt(28) lgkmcnt(0)
  s_barrier
  s_add_u32 m0, s52, 0
  s_add_u32 s38, s45, 1048576
  buffer_load_dwordx4 v3, s[16:19], s38 offen lds
  s_add_u32 m0, s52, 1024
  s_add_u32 s38, s45, 1114112
  buffer_load_dwordx4 v3, s[16:19], s38 offen lds
  s_add_u32 m0, s52, 2048
  s_add_u32 s38, s45, 1056768
  buffer_load_dwordx4 v3, s[16:19], s38 offen lds
  s_add_u32 m0, s52, 3072
  s_add_u32 s38, s45, 1122304
  buffer_load_dwordx4 v3, s[16:19], s38 offen lds
  ds_read_b64_tr_b16 a[160:161], v100 offset:4096
  ds_read_b64_tr_b16 a[162:163], v100 offset:6144
  ds_read_b64_tr_b16 a[164:165], v102 offset:4096
  ds_read_b64_tr_b16 a[166:167], v102 offset:6144
  ds_read_b64_tr_b16 a[168:169], v101 offset:4096
  ds_read_b64_tr_b16 a[170:171], v101 offset:6144
  ds_read_b64_tr_b16 a[172:173], v103 offset:4096
  ds_read_b64_tr_b16 a[174:175], v103 offset:6144
  s_waitcnt vmcnt(28) lgkmcnt(0)
  s_barrier
  s_add_u32 m0, s52, 4096
  s_add_u32 s38, s45, 1572864
  buffer_load_dwordx4 v3, s[16:19], s38 offen lds
  s_add_u32 m0, s52, 5120
  s_add_u32 s38, s45, 1638400
  buffer_load_dwordx4 v3, s[16:19], s38 offen lds
  s_add_u32 m0, s52, 6144
  s_add_u32 s38, s45, 1581056
  buffer_load_dwordx4 v3, s[16:19], s38 offen lds
  s_add_u32 m0, s52, 7168
  s_add_u32 s38, s45, 1646592
  buffer_load_dwordx4 v3, s[16:19], s38 offen lds
  ds_read_b64_tr_b16 a[176:177], v100 offset:8192
  ds_read_b64_tr_b16 a[178:179], v100 offset:10240
  ds_read_b64_tr_b16 a[180:181], v102 offset:8192
  ds_read_b64_tr_b16 a[182:183], v102 offset:10240
  ds_read_b64_tr_b16 a[184:185], v101 offset:8192
  ds_read_b64_tr_b16 a[186:187], v101 offset:10240
  ds_read_b64_tr_b16 a[188:189], v103 offset:8192
  ds_read_b64_tr_b16 a[190:191], v103 offset:10240
  s_waitcnt vmcnt(28) lgkmcnt(0)
  s_barrier
  s_add_u32 m0, s52, 8192
  s_add_u32 s38, s45, 2097152
  buffer_load_dwordx4 v3, s[16:19], s38 offen lds
  s_add_u32 m0, s52, 9216
  s_add_u32 s38, s45, 2162688
  buffer_load_dwordx4 v3, s[16:19], s38 offen lds
  s_add_u32 m0, s52, 10240
  s_add_u32 s38, s45, 2105344
  buffer_load_dwordx4 v3, s[16:19], s38 offen lds
  s_add_u32 m0, s52, 11264
  s_add_u32 s38, s45, 2170880
  buffer_load_dwordx4 v3, s[16:19], s38 offen lds
  ds_read_b64_tr_b16 a[192:193], v100 offset:12288
  ds_read_b64_tr_b16 a[194:195], v100 offset:14336
  ds_read_b64_tr_b16 a[196:197], v102 offset:12288
  ds_read_b64_tr_b16 a[198:199], v102 offset:14336
  ds_read_b64_tr_b16 a[200:201], v101 offset:12288
  ds_read_b64_tr_b16 a[202:203], v101 offset:14336
  ds_read_b64_tr_b16 a[204:205], v103 offset:12288
  ds_read_b64_tr_b16 a[206:207], v103 offset:14336
  s_waitcnt vmcnt(28) lgkmcnt(0)
  s_barrier
  s_add_u32 m0, s52, 12288
  s_add_u32 s38, s45, 2621440
  buffer_load_dwordx4 v3, s[16:19], s38 offen lds
  s_add_u32 m0, s52, 13312
  s_add_u32 s38, s45, 2686976
  buffer_load_dwordx4 v3, s[16:19], s38 offen lds
  s_add_u32 m0, s52, 14336
  s_add_u32 s38, s45, 2629632
  buffer_load_dwordx4 v3, s[16:19], s38 offen lds
  s_add_u32 m0, s52, 15360
  s_add_u32 s38, s45, 2695168
  buffer_load_dwordx4 v3, s[16:19], s38 offen lds
  ds_read_b64_tr_b16 a[208:209], v100 offset:16384
  ds_read_b64_tr_b16 a[210:211], v100 offset:18432
  ds_read_b64_tr_b16 a[212:213], v102 offset:16384
  ds_read_b64_tr_b16 a[214:215], v102 offset:18432
  ds_read_b64_tr_b16 a[216:217], v101 offset:16384
  ds_read_b64_tr_b16 a[218:219], v101 offset:18432
  ds_read_b64_tr_b16 a[220:221], v103 offset:16384
  ds_read_b64_tr_b16 a[222:223], v103 offset:18432
  s_waitcnt vmcnt(28) lgkmcnt(0)
  s_barrier
  s_add_u32 m0, s52, 16384
  s_add_u32 s38, s45, 3145728
  buffer_load_dwordx4 v3, s[16:19], s38 offen lds
  s_add_u32 m0, s52, 17408
  s_add_u32 s38, s45, 3211264
  buffer_load_dwordx4 v3, s[16:19], s38 offen lds
  s_add_u32 m0, s52, 18432
  s_add_u32 s38, s45, 3153920
  buffer_load_dwordx4 v3, s[16:19], s38 offen lds
  s_add_u32 m0, s52, 19456
  s_add_u32 s38, s45, 3219456
  buffer_load_dwordx4 v3, s[16:19], s38 offen lds
  ds_read_b64_tr_b16 a[224:225], v100 offset:20480
  ds_read_b64_tr_b16 a[226:227], v100 offset:22528
  ds_read_b64_tr_b16 a[228:229], v102 offset:20480
  ds_read_b64_tr_b16 a[230:231], v102 offset:22528
  ds_read_b64_tr_b16 a[232:233], v101 offset:20480
  ds_read_b64_tr_b16 a[234:235], v101 offset:22528
  ds_read_b64_tr_b16 a[236:237], v103 offset:20480
  ds_read_b64_tr_b16 a[238:239], v103 offset:22528
  s_waitcnt vmcnt(28) lgkmcnt(0)
  s_barrier
  s_add_u32 m0, s52, 20480
  s_add_u32 s38, s45, 3670016
  buffer_load_dwordx4 v3, s[16:19], s38 offen lds
  s_add_u32 m0, s52, 21504
  s_add_u32 s38, s45, 3735552
  buffer_load_dwordx4 v3, s[16:19], s38 offen lds
  s_add_u32 m0, s52, 22528
  s_add_u32 s38, s45, 3678208
  buffer_load_dwordx4 v3, s[16:19], s38 offen lds
  s_add_u32 m0, s52, 23552
  s_add_u32 s38, s45, 3743744
  buffer_load_dwordx4 v3, s[16:19], s38 offen lds
  ds_read_b64_tr_b16 a[240:241], v100 offset:24576
  ds_read_b64_tr_b16 a[242:243], v100 offset:26624
  ds_read_b64_tr_b16 a[244:245], v102 offset:24576
  ds_read_b64_tr_b16 a[246:247], v102 offset:26624
  ds_read_b64_tr_b16 a[248:249], v101 offset:24576
  ds_read_b64_tr_b16 a[250:251], v101 offset:26624
  ds_read_b64_tr_b16 a[252:253], v103 offset:24576
  ds_read_b64_tr_b16 a[254:255], v103 offset:26624
  s_waitcnt vmcnt(28) lgkmcnt(0)
  s_barrier
  ds_read_b64_tr_b16 v[128:129], v100 offset:28672
  ds_read_b64_tr_b16 v[130:131], v100 offset:30720
  ds_read_b64_tr_b16 v[132:133], v102 offset:28672
  ds_read_b64_tr_b16 v[134:135], v102 offset:30720
  ds_read_b64_tr_b16 v[136:137], v101 offset:28672
  ds_read_b64_tr_b16 v[138:139], v101 offset:30720
  ds_read_b64_tr_b16 v[140:141], v103 offset:28672
  ds_read_b64_tr_b16 v[142:143], v103 offset:30720
  s_waitcnt vmcnt(24) lgkmcnt(0)
  s_barrier
  ds_read_b64_tr_b16 v[144:145], v100 offset:32768
  ds_read_b64_tr_b16 v[146:147], v100 offset:34816
  ds_read_b64_tr_b16 v[148:149], v102 offset:32768
  ds_read_b64_tr_b16 v[150:151], v102 offset:34816
  ds_read_b64_tr_b16 v[152:153], v101 offset:32768
  ds_read_b64_tr_b16 v[154:155], v101 offset:34816
  ds_read_b64_tr_b16 v[156:157], v103 offset:32768
  ds_read_b64_tr_b16 v[158:159], v103 offset:34816
  s_waitcnt vmcnt(20) lgkmcnt(0)
  s_barrier
  ds_read_b64_tr_b16 v[160:161], v100 offset:0
  ds_read_b64_tr_b16 v[162:163], v100 offset:2048
  ds_read_b64_tr_b16 v[164:165], v102 offset:0
  ds_read_b64_tr_b16 v[166:167], v102 offset:2048
  ds_read_b64_tr_b16 v[168:169], v101 offset:0
  ds_read_b64_tr_b16 v[170:171], v101 offset:2048
  ds_read_b64_tr_b16 v[172:173], v103 offset:0
  ds_read_b64_tr_b16 v[174:175], v103 offset:2048
  s_waitcnt vmcnt(16) lgkmcnt(0)
  s_barrier
  ds_read_b64_tr_b16 v[176:177], v100 offset:4096
  ds_read_b64_tr_b16 v[178:179], v100 offset:6144
  ds_read_b64_tr_b16 v[180:181], v102 offset:4096
  ds_read_b64_tr_b16 v[182:183], v102 offset:6144
  ds_read_b64_tr_b16 v[184:185], v101 offset:4096
  ds_read_b64_tr_b16 v[186:187], v101 offset:6144
  ds_read_b64_tr_b16 v[188:189], v103 offset:4096
  ds_read_b64_tr_b16 v[190:191], v103 offset:6144
  s_waitcnt vmcnt(12) lgkmcnt(0)
  s_barrier
  ds_read_b64_tr_b16 v[192:193], v100 offset:8192
  ds_read_b64_tr_b16 v[194:195], v100 offset:10240
  ds_read_b64_tr_b16 v[196:197], v102 offset:8192
  ds_read_b64_tr_b16 v[198:199], v102 offset:10240
  ds_read_b64_tr_b16 v[200:201], v101 offset:8192
  ds_read_b64_tr_b16 v[202:203], v101 offset:10240
  ds_read_b64_tr_b16 v[204:205], v103 offset:8192
  ds_read_b64_tr_b16 v[206:207], v103 offset:10240
  s_waitcnt vmcnt(8) lgkmcnt(0)
  s_barrier
  ds_read_b64_tr_b16 v[208:209], v100 offset:12288
  ds_read_b64_tr_b16 v[210:211], v100 offset:14336
  ds_read_b64_tr_b16 v[212:213], v102 offset:12288
  ds_read_b64_tr_b16 v[214:215], v102 offset:14336
  ds_read_b64_tr_b16 v[216:217], v101 offset:12288
  ds_read_b64_tr_b16 v[218:219], v101 offset:14336
  ds_read_b64_tr_b16 v[220:221], v103 offset:12288
  ds_read_b64_tr_b16 v[222:223], v103 offset:14336
  s_waitcnt vmcnt(4) lgkmcnt(0)
  s_barrier
  ds_read_b64_tr_b16 v[224:225], v100 offset:16384
  ds_read_b64_tr_b16 v[226:227], v100 offset:18432
  ds_read_b64_tr_b16 v[228:229], v102 offset:16384
  ds_read_b64_tr_b16 v[230:231], v102 offset:18432
  ds_read_b64_tr_b16 v[232:233], v101 offset:16384
  ds_read_b64_tr_b16 v[234:235], v101 offset:18432
  ds_read_b64_tr_b16 v[236:237], v103 offset:16384
  ds_read_b64_tr_b16 v[238:239], v103 offset:18432
  s_waitcnt vmcnt(0) lgkmcnt(0)
  s_barrier
  ds_read_b64_tr_b16 v[240:241], v100 offset:20480
  ds_read_b64_tr_b16 v[242:243], v100 offset:22528
  ds_read_b64_tr_b16 v[244:245], v102 offset:20480
  ds_read_b64_tr_b16 v[246:247], v102 offset:22528
  ds_read_b64_tr_b16 v[248:249], v101 offset:20480
  ds_read_b64_tr_b16 v[250:251], v101 offset:22528
  ds_read_b64_tr_b16 v[252:253], v103 offset:20480
  ds_read_b64_tr_b16 v[254:255], v103 offset:22528
  s_waitcnt lgkmcnt(0)
  s_barrier
  s_cmp_lg_u32 s95, 0
  s_cbranch_scc1 qkv_conf
  s_mov_b32 s95, 1
  s_barrier
  v_mov_b32 v14, 163836
  ds_read_b32 v14, v14
  s_waitcnt lgkmcnt(0)
  v_readfirstlane_b32 s36, v14
  s_barrier
  s_cmp_eq_u32 s36, s94
  s_cbranch_scc1 qkv_conf
  s_mov_b32 s94, s36
  s_waitcnt vmcnt(0)
  s_barrier
  s_branch L_role
qkv_conf:
  s_cmp_lg_u32 s32, 0
  s_cbranch_scc1 qkv_xn_ok
  v_mov_b32 v9, 192
qkv_xn:
  buffer_load_dword v8, v9, s[12:15], 0 offen sc1
  s_waitcnt vmcnt(0)
  v_readfirstlane_b32 s39, v8
  s_nop 0
  s_and_b32 s36, s39, 0xffff
  s_cmp_ge_u32 s36, 64
  s_cbranch_scc1 qkv_xn_ok
  s_sleep 2
  s_sub_u32 s35, s35, 1
  s_cbranch_scc0 qkv_xn
  s_mov_b32 s35, 0
qkv_xn_ok:
  s_barrier
  v_mov_b64 v[96:97], -1
  v_mov_b64 v[98:99], -1
  s_mov_b32 s68, 1040356334
  s_lshl_b32 s43, s32, 13
  s_add_u32 s42, s43, 2097152
  v_mov_b32 v4, v0
  s_mov_b32 s44, -1
  s_min_u32 s36, s40, 63
  s_lshl_b32 s36, s36, 15
  s_add_u32 s36, s36, s42
  s_add_u32 s37, s36, 4096
  s_mov_b32 m0, s43
  s_nop 0
  buffer_load_dwordx4 v0, s[8:11], s36 offen offset:0 sc1 lds
  buffer_load_dwordx4 v0, s[8:11], s36 offen offset:1024 sc1 lds
  buffer_load_dwordx4 v0, s[8:11], s36 offen offset:2048 sc1 lds
  buffer_load_dwordx4 v0, s[8:11], s36 offen offset:3072 sc1 lds
  s_add_u32 m0, s43, 4096
  s_nop 0
  buffer_load_dwordx4 v0, s[8:11], s37 offen offset:0 sc1 lds
  buffer_load_dwordx4 v0, s[8:11], s37 offen offset:1024 sc1 lds
  buffer_load_dwordx4 v0, s[8:11], s37 offen offset:2048 sc1 lds
  buffer_load_dwordx4 v0, s[8:11], s37 offen offset:3072 sc1 lds
  s_xor_b32 s43, s43, 0x8000
  s_waitcnt vmcnt(0)
qkv_top:
  s_barrier
  s_add_u32 s41, s40, 6
  s_sub_u32 s36, 14, s89
  s_cmp_lt_u32 s40, 9
  s_cselect_b32 s41, s36, s41
  s_add_u32 s36, s40, 3
  s_cmp_lt_u32 s40, 3
  s_cselect_b32 s41, s36, s41
  s_min_u32 s36, s41, 63
  s_lshl_b32 s36, s36, 15
  s_add_u32 s36, s36, s42
  s_add_u32 s37, s36, 4096
  s_mov_b32 m0, s43
  s_nop 0
  buffer_load_dwordx4 v0, s[8:11], s36 offen offset:0 sc1 lds
  buffer_load_dwordx4 v0, s[8:11], s36 offen offset:1024 sc1 lds
  buffer_load_dwordx4 v0, s[8:11], s36 offen offset:2048 sc1 lds
  buffer_load_dwordx4 v0, s[8:11], s36 offen offset:3072 sc1 lds
  s_add_u32 m0, s43, 4096
  s_nop 0
  buffer_load_dwordx4 v0, s[8:11], s37 offen offset:0 sc1 lds
  buffer_load_dwordx4 v0, s[8:11], s37 offen offset:1024 sc1 lds
  buffer_load_dwordx4 v0, s[8:11], s37 offen offset:2048 sc1 lds
  buffer_load_dwordx4 v0, s[8:11], s37 offen offset:3072 sc1 lds
  s_xor_b32 s43, s43, 0x8000
  ds_read_b128 v[8:11], v4 offset:0
  ds_read_b128 v[12:15], v4 offset:16384
  s_waitcnt lgkmcnt(0)
  ds_read_b128 v[16:19], v4 offset:1024
  ds_read_b128 v[20:23], v4 offset:17408
  v_mfma_f32_16x16x32_bf16 v[24:27], v[128:131], v[8:11], 0
  v_mfma_f32_16x16x32_bf16 v[28:31], v[128:131], v[12:15], 0
  v_mfma_f32_16x16x32_bf16 v[32:35], v[136:139], v[8:11], 0
  v_mfma_f32_16x16x32_bf16 v[36:39], v[136:139], v[12:15], 0
  v_mfma_f32_16x16x32_bf16 v[40:43], a[0:3], v[8:11], 0
  v_mfma_f32_16x16x32_bf16 v[44:47], a[0:3], v[12:15], 0
  v_mfma_f32_16x16x32_bf16 v[48:51], a[8:11], v[8:11], 0
  v_mfma_f32_16x16x32_bf16 v[52:55], a[8:11], v[12:15], 0
  v_mfma_f32_16x16x32_bf16 v[56:59], v[8:11], a[128:131], 0
  v_mfma_f32_16x16x32_bf16 v[60:63], v[12:15], a[128:131], 0
  v_mfma_f32_16x16x32_bf16 v[64:67], v[8:11], a[136:139], 0
  v_mfma_f32_16x16x32_bf16 v[68:71], v[12:15], a[136:139], 0
  s_waitcnt lgkmcnt(0)
  ds_read_b128 v[8:11], v4 offset:2048
  ds_read_b128 v[12:15], v4 offset:18432
  v_mfma_f32_16x16x32_bf16 v[24:27], v[132:135], v[16:19], v[24:27]
  v_mfma_f32_16x16x32_bf16 v[28:31], v[132:135], v[20:23], v[28:31]
  v_mfma_f32_16x16x32_bf16 v[32:35], v[140:143], v[16:19], v[32:35]
  v_mfma_f32_16x16x32_bf16 v[36:39], v[140:143], v[20:23], v[36:39]
  v_mfma_f32_16x16x32_bf16 v[40:43], a[4:7], v[16:19], v[40:43]
  v_mfma_f32_16x16x32_bf16 v[44:47], a[4:7], v[20:23], v[44:47]
  v_mfma_f32_16x16x32_bf16 v[48:51], a[12:15], v[16:19], v[48:51]
  v_mfma_f32_16x16x32_bf16 v[52:55], a[12:15], v[20:23], v[52:55]
  v_mfma_f32_16x16x32_bf16 v[56:59], v[16:19], a[132:135], v[56:59]
  v_mfma_f32_16x16x32_bf16 v[60:63], v[20:23], a[132:135], v[60:63]
  v_mfma_f32_16x16x32_bf16 v[64:67], v[16:19], a[140:143], v[64:67]
  v_mfma_f32_16x16x32_bf16 v[68:71], v[20:23], a[140:143], v[68:71]
  s_waitcnt lgkmcnt(0)
  ds_read_b128 v[16:19], v4 offset:3072
  ds_read_b128 v[20:23], v4 offset:19456
  v_mfma_f32_16x16x32_bf16 v[24:27], v[144:147], v[8:11], v[24:27]
  v_mfma_f32_16x16x32_bf16 v[28:31], v[144:147], v[12:15], v[28:31]
  v_mfma_f32_16x16x32_bf16 v[32:35], v[152:155], v[8:11], v[32:35]
  v_mfma_f32_16x16x32_bf16 v[36:39], v[152:155], v[12:15], v[36:39]
  v_mfma_f32_16x16x32_bf16 v[40:43], a[16:19], v[8:11], v[40:43]
  v_mfma_f32_16x16x32_bf16 v[44:47], a[16:19], v[12:15], v[44:47]
  v_mfma_f32_16x16x32_bf16 v[48:51], a[24:27], v[8:11], v[48:51]
  v_mfma_f32_16x16x32_bf16 v[52:55], a[24:27], v[12:15], v[52:55]
  v_mfma_f32_16x16x32_bf16 v[56:59], v[8:11], a[144:147], v[56:59]
  v_mfma_f32_16x16x32_bf16 v[60:63], v[12:15], a[144:147], v[60:63]
  v_mfma_f32_16x16x32_bf16 v[64:67], v[8:11], a[152:155], v[64:67]
  v_mfma_f32_16x16x32_bf16 v[68:71], v[12:15], a[152:155], v[68:71]
  s_waitcnt lgkmcnt(0)
  ds_read_b128 v[8:11], v4 offset:4096
  ds_read_b128 v[12:15], v4 offset:20480
  v_mfma_f32_16x16x32_bf16 v[24:27], v[148:151], v[16:19], v[24:27]
  v_mfma_f32_16x16x32_bf16 v[28:31], v[148:151], v[20:23], v[28:31]
  v_mfma_f32_16x16x32_bf16 v[32:35], v[156:159], v[16:19], v[32:35]
  v_mfma_f32_16x16x32_bf16 v[36:39], v[156:159], v[20:23], v[36:39]
  v_mfma_f32_16x16x32_bf16 v[40:43], a[20:23], v[16:19], v[40:43]
  v_mfma_f32_16x16x32_bf16 v[44:47], a[20:23], v[20:23], v[44:47]
  v_mfma_f32_16x16x32_bf16 v[48:51], a[28:31], v[16:19], v[48:51]
  v_mfma_f32_16x16x32_bf16 v[52:55], a[28:31], v[20:23], v[52:55]
  v_mfma_f32_16x16x32_bf16 v[56:59], v[16:19], a[148:151], v[56:59]
  v_mfma_f32_16x16x32_bf16 v[60:63], v[20:23], a[148:151], v[60:63]
  v_mfma_f32_16x16x32_bf16 v[64:67], v[16:19], a[156:159], v[64:67]
  v_mfma_f32_16x16x32_bf16 v[68:71], v[20:23], a[156:159], v[68:71]
  s_waitcnt lgkmcnt(0)
  ds_read_b128 v[16:19], v4 offset:5120
  ds_read_b128 v[20:23], v4 offset:21504
  v_mfma_f32_16x16x32_bf16 v[24:27], v[160:163], v[8:11], v[24:27]
  v_mfma_f32_16x16x32_bf16 v[28:31], v[160:163], v[12:15], v[28:31]
  v_mfma_f32_16x16x32_bf16 v[32:35], v[168:171], v[8:11], v[32:35]
  v_mfma_f32_16x16x32_bf16 v[36:39], v[168:171], v[12:15], v[36:39]
  v_mfma_f32_16x16x32_bf16 v[40:43], a[32:35], v[8:11], v[40:43]
  v_mfma_f32_16x16x32_bf16 v[44:47], a[32:35], v[12:15], v[44:47]
  v_mfma_f32_16x16x32_bf16 v[48:51], a[40:43], v[8:11], v[48:51]
  v_mfma_f32_16x16x32_bf16 v[52:55], a[40:43], v[12:15], v[52:55]
  v_mfma_f32_16x16x32_bf16 v[56:59], v[8:11], a[160:163], v[56:59]
  v_mfma_f32_16x16x32_bf16 v[60:63], v[12:15], a[160:163], v[60:63]
  v_mfma_f32_16x16x32_bf16 v[64:67], v[8:11], a[168:171], v[64:67]
  v_mfma_f32_16x16x32_bf16 v[68:71], v[12:15], a[168:171], v[68:71]
  s_waitcnt lgkmcnt(0)
  ds_read_b128 v[8:11], v4 offset:6144
  ds_read_b128 v[12:15], v4 offset:22528
  v_mfma_f32_16x16x32_bf16 v[24:27], v[164:167], v[16:19], v[24:27]
  v_mfma_f32_16x16x32_bf16 v[28:31], v[164:167], v[20:23], v[28:31]
  v_mfma_f32_16x16x32_bf16 v[32:35], v[172:175], v[16:19], v[32:35]
  v_mfma_f32_16x16x32_bf16 v[36:39], v[172:175], v[20:23], v[36:39]
  v_mfma_f32_16x16x32_bf16 v[40:43], a[36:39], v[16:19], v[40:43]
  v_mfma_f32_16x16x32_bf16 v[44:47], a[36:39], v[20:23], v[44:47]
  v_mfma_f32_16x16x32_bf16 v[48:51], a[44:47], v[16:19], v[48:51]
  v_mfma_f32_16x16x32_bf16 v[52:55], a[44:47], v[20:23], v[52:55]
  v_mfma_f32_16x16x32_bf16 v[56:59], v[16:19], a[164:167], v[56:59]
  v_mfma_f32_16x16x32_bf16 v[60:63], v[20:23], a[164:167], v[60:63]
  v_mfma_f32_16x16x32_bf16 v[64:67], v[16:19], a[172:175], v[64:67]
  v_mfma_f32_16x16x32_bf16 v[68:71], v[20:23], a[172:175], v[68:71]
  s_waitcnt vmcnt(0)
  s_cmp_lt_i32 s44, 0
  s_cbranch_scc1 qkv_noflag
  s_lshl_b32 s36, s33, 8
  s_lshl_b32 s37, s44, 2
  s_add_u32 s36, s36, s37
  s_mov_b64 exec, 1
  v_mov_b32 v6, 1
  v_mov_b32 v7, 0
  buffer_atomic_add v6, v7, s[8:11], s36 offen sc1
  s_mov_b64 exec, -1
qkv_noflag:
  s_waitcnt lgkmcnt(0)
  ds_read_b128 v[16:19], v4 offset:7168
  ds_read_b128 v[20:23], v4 offset:23552
  v_mfma_f32_16x16x32_bf16 v[24:27], v[176:179], v[8:11], v[24:27]
  v_mfma_f32_16x16x32_bf16 v[28:31], v[176:179], v[12:15], v[28:31]
  v_mfma_f32_16x16x32_bf16 v[32:35], v[184:187], v[8:11], v[32:35]
  v_mfma_f32_16x16x32_bf16 v[36:39], v[184:187], v[12:15], v[36:39]
  v_mfma_f32_16x16x32_bf16 v[40:43], a[48:51], v[8:11], v[40:43]
  v_mfma_f32_16x16x32_bf16 v[44:47], a[48:51], v[12:15], v[44:47]
  v_mfma_f32_16x16x32_bf16 v[48:51], a[56:59], v[8:11], v[48:51]
  v_mfma_f32_16x16x32_bf16 v[52:55], a[56:59], v[12:15], v[52:55]
  v_mfma_f32_16x16x32_bf16 v[56:59], v[8:11], a[176:179], v[56:59]
  v_mfma_f32_16x16x32_bf16 v[60:63], v[12:15], a[176:179], v[60:63]
  v_mfma_f32_16x16x32_bf16 v[64:67], v[8:11], a[184:187], v[64:67]
  v_mfma_f32_16x16x32_bf16 v[68:71], v[12:15], a[184:187], v[68:71]
  s_waitcnt lgkmcnt(0)
  ds_read_b128 v[8:11], v4 offset:8192
  ds_read_b128 v[12:15], v4 offset:24576
  v_mfma_f32_16x16x32_bf16 v[24:27], v[180:183], v[16:19], v[24:27]
  v_mfma_f32_16x16x32_bf16 v[28:31], v[180:183], v[20:23], v[28:31]
  v_mfma_f32_16x16x32_bf16 v[32:35], v[188:191], v[16:19], v[32:35]
  v_mfma_f32_16x16x32_bf16 v[36:39], v[188:191], v[20:23], v[36:39]
  v_mfma_f32_16x16x32_bf16 v[40:43], a[52:55], v[16:19], v[40:43]
  v_mfma_f32_16x16x32_bf16 v[44:47], a[52:55], v[20:23], v[44:47]
  v_mfma_f32_16x16x32_bf16 v[48:51], a[60:63], v[16:19], v[48:51]
  v_mfma_f32_16x16x32_bf16 v[52:55], a[60:63], v[20:23], v[52:55]
  v_mfma_f32_16x16x32_bf16 v[56:59], v[16:19], a[180:183], v[56:59]
  v_mfma_f32_16x16x32_bf16 v[60:63], v[20:23], a[180:183], v[60:63]
  v_mfma_f32_16x16x32_bf16 v[64:67], v[16:19], a[188:191], v[64:67]
  v_mfma_f32_16x16x32_bf16 v[68:71], v[20:23], a[188:191], v[68:71]
  s_waitcnt lgkmcnt(0)
  ds_read_b128 v[16:19], v4 offset:9216
  ds_read_b128 v[20:23], v4 offset:25600
  v_mfma_f32_16x16x32_bf16 v[24:27], v[192:195], v[8:11], v[24:27]
  v_mfma_f32_16x16x32_bf16 v[28:31], v[192:195], v[12:15], v[28:31]
  v_mfma_f32_16x16x32_bf16 v[32:35], v[200:203], v[8:11], v[32:35]
  v_mfma_f32_16x16x32_bf16 v[36:39], v[200:203], v[12:15], v[36:39]
  v_mfma_f32_16x16x32_bf16 v[40:43], a[64:67], v[8:11], v[40:43]
  v_mfma_f32_16x16x32_bf16 v[44:47], a[64:67], v[12:15], v[44:47]
  v_mfma_f32_16x16x32_bf16 v[48:51], a[72:75], v[8:11], v[48:51]
  v_mfma_f32_16x16x32_bf16 v[52:55], a[72:75], v[12:15], v[52:55]
  v_mfma_f32_16x16x32_bf16 v[56:59], v[8:11], a[192:195], v[56:59]
  v_mfma_f32_16x16x32_bf16 v[60:63], v[12:15], a[192:195], v[60:63]
  v_mfma_f32_16x16x32_bf16 v[64:67], v[8:11], a[200:203], v[64:67]
  v_mfma_f32_16x16x32_bf16 v[68:71], v[12:15], a[200:203], v[68:71]
  s_waitcnt lgkmcnt(0)
  ds_read_b128 v[8:11], v4 offset:10240
  ds_read_b128 v[12:15], v4 offset:26624
  v_mfma_f32_16x16x32_bf16 v[24:27], v[196:199], v[16:19], v[24:27]
  v_mfma_f32_16x16x32_bf16 v[28:31], v[196:199], v[20:23], v[28:31]
  v_mfma_f32_16x16x32_bf16 v[32:35], v[204:207], v[16:19], v[32:35]
  v_mfma_f32_16x16x32_bf16 v[36:39], v[204:207], v[20:23], v[36:39]
  v_mfma_f32_16x16x32_bf16 v[40:43], a[68:71], v[16:19], v[40:43]
  v_mfma_f32_16x16x32_bf16 v[44:47], a[68:71], v[20:23], v[44:47]
  v_mfma_f32_16x16x32_bf16 v[48:51], a[76:79], v[16:19], v[48:51]
  v_mfma_f32_16x16x32_bf16 v[52:55], a[76:79], v[20:23], v[52:55]
  v_mfma_f32_16x16x32_bf16 v[56:59], v[16:19], a[196:199], v[56:59]
  v_mfma_f32_16x16x32_bf16 v[60:63], v[20:23], a[196:199], v[60:63]
  v_mfma_f32_16x16x32_bf16 v[64:67], v[16:19], a[204:207], v[64:67]
  v_mfma_f32_16x16x32_bf16 v[68:71], v[20:23], a[204:207], v[68:71]
  s_waitcnt lgkmcnt(0)
  ds_read_b128 v[16:19], v4 offset:11264
  ds_read_b128 v[20:23], v4 offset:27648
  v_mfma_f32_16x16x32_bf16 v[24:27], v[208:211], v[8:11], v[24:27]
  v_mfma_f32_16x16x32_bf16 v[28:31], v[208:211], v[12:15], v[28:31]
  v_mfma_f32_16x16x32_bf16 v[32:35], v[216:219], v[8:11], v[32:35]
  v_mfma_f32_16x16x32_bf16 v[36:39], v[216:219], v[12:15], v[36:39]
  v_mfma_f32_16x16x32_bf16 v[40:43], a[80:83], v[8:11], v[40:43]
  v_mfma_f32_16x16x32_bf16 v[44:47], a[80:83], v[12:15], v[44:47]
  v_mfma_f32_16x16x32_bf16 v[48:51], a[88:91], v[8:11], v[48:51]
  v_mfma_f32_16x16x32_bf16 v[52:55], a[88:91], v[12:15], v[52:55]
  v_mfma_f32_16x16x32_bf16 v[56:59], v[8:11], a[208:211], v[56:59]
  v_mfma_f32_16x16x32_bf16 v[60:63], v[12:15], a[208:211], v[60:63]
  v_mfma_f32_16x16x32_bf16 v[64:67], v[8:11], a[216:219], v[64:67]
  v_mfma_f32_16x16x32_bf16 v[68:71], v[12:15], a[216:219], v[68:71]
  s_waitcnt lgkmcnt(0)
  ds_read_b128 v[8:11], v4 offset:12288
  ds_read_b128 v[12:15], v4 offset:28672
  v_mfma_f32_16x16x32_bf16 v[24:27], v[212:215], v[16:19], v[24:27]
  v_mfma_f32_16x16x32_bf16 v[28:31], v[212:215], v[20:23], v[28:31]
  v_mfma_f32_16x16x32_bf16 v[32:35], v[220:223], v[16:19], v[32:35]
  v_mfma_f32_16x16x32_bf16 v[36:39], v[220:223], v[20:23], v[36:39]
  v_mfma_f32_16x16x32_bf16 v[40:43], a[84:87], v[16:19], v[40:43]
  v_mfma_f32_16x16x32_bf16 v[44:47], a[84:87], v[20:23], v[44:47]
  v_mfma_f32_16x16x32_bf16 v[48:51], a[92:95], v[16:19], v[48:51]
  v_mfma_f32_16x16x32_bf16 v[52:55], a[92:95], v[20:23], v[52:55]
  v_mfma_f32_16x16x32_bf16 v[56:59], v[16:19], a[212:215], v[56:59]
  v_mfma_f32_16x16x32_bf16 v[60:63], v[20:23], a[212:215], v[60:63]
  v_mfma_f32_16x16x32_bf16 v[64:67], v[16:19], a[220:223], v[64:67]
  v_mfma_f32_16x16x32_bf16 v[68:71], v[20:23], a[220:223], v[68:71]
  s_waitcnt lgkmcnt(0)
  ds_read_b128 v[16:19], v4 offset:13312
  ds_read_b128 v[20:23], v4 offset:29696
  v_mfma_f32_16x16x32_bf16 v[24:27], v[224:227], v[8:11], v[24:27]
  v_mfma_f32_16x16x32_bf16 v[28:31], v[224:227], v[12:15], v[28:31]
  v_mfma_f32_16x16x32_bf16 v[32:35], v[232:235], v[8:11], v[32:35]
  v_mfma_f32_16x16x32_bf16 v[36:39], v[232:235], v[12:15], v[36:39]
  v_mfma_f32_16x16x32_bf16 v[40:43], a[96:99], v[8:11], v[40:43]
  v_mfma_f32_16x16x32_bf16 v[44:47], a[96:99], v[12:15], v[44:47]
  v_mfma_f32_16x16x32_bf16 v[48:51], a[104:107], v[8:11], v[48:51]
  v_mfma_f32_16x16x32_bf16 v[52:55], a[104:107], v[12:15], v[52:55]
  v_mfma_f32_16x16x32_bf16 v[56:59], v[8:11], a[224:227], v[56:59]
  v_mfma_f32_16x16x32_bf16 v[60:63], v[12:15], a[224:227], v[60:63]
  v_mfma_f32_16x16x32_bf16 v[64:67], v[8:11], a[232:235], v[64:67]
  v_mfma_f32_16x16x32_bf16 v[68:71], v[12:15], a[232:235], v[68:71]
  s_waitcnt lgkmcnt(0)
  ds_read_b128 v[8:11], v4 offset:14336
  ds_read_b128 v[12:15], v4 offset:30720
  v_mfma_f32_16x16x32_bf16 v[24:27], v[228:231], v[16:19], v[24:27]
  v_mfma_f32_16x16x32_bf16 v[28:31], v[228:231], v[20:23], v[28:31]
  v_mfma_f32_16x16x32_bf16 v[32:35], v[236:239], v[16:19], v[32:35]
  v_mfma_f32_16x16x32_bf16 v[36:39], v[236:239], v[20:23], v[36:39]
  v_mfma_f32_16x16x32_bf16 v[40:43], a[100:103], v[16:19], v[40:43]
  v_mfma_f32_16x16x32_bf16 v[44:47], a[100:103], v[20:23], v[44:47]
  v_mfma_f32_16x16x32_bf16 v[48:51], a[108:111], v[16:19], v[48:51]
  v_mfma_f32_16x16x32_bf16 v[52:55], a[108:111], v[20:23], v[52:55]
  v_mfma_f32_16x16x32_bf16 v[56:59], v[16:19], a[228:231], v[56:59]
  v_mfma_f32_16x16x32_bf16 v[60:63], v[20:23], a[228:231], v[60:63]
  v_mfma_f32_16x16x32_bf16 v[64:67], v[16:19], a[236:239], v[64:67]
  v_mfma_f32_16x16x32_bf16 v[68:71], v[20:23], a[236:239], v[68:71]
  s_waitcnt lgkmcnt(0)
  ds_read_b128 v[16:19], v4 offset:15360
  ds_read_b128 v[20:23], v4 offset:31744
  v_mfma_f32_16x16x32_bf16 v[24:27], v[240:243], v[8:11], v[24:27]
  v_mfma_f32_16x16x32_bf16 v[28:31], v[240:243], v[12:15], v[28:31]
  v_mfma_f32_16x16x32_bf16 v[32:35], v[248:251], v[8:11], v[32:35]
  v_mfma_f32_16x16x32_bf16 v[36:39], v[248:251], v[12:15], v[36:39]
  v_mfma_f32_16x16x32_bf16 v[40:43], a[112:115], v[8:11], v[40:43]
  v_mfma_f32_16x16x32_bf16 v[44:47], a[112:115], v[12:15], v[44:47]
  v_mfma_f32_16x16x32_bf16 v[48:51], a[120:123], v[8:11], v[48:51]
  v_mfma_f32_16x16x32_bf16 v[52:55], a[120:123], v[12:15], v[52:55]
  v_mfma_f32_16x16x32_bf16 v[56:59], v[8:11], a[240:243], v[56:59]
  v_mfma_f32_16x16x32_bf16 v[60:63], v[12:15], a[240:243], v[60:63]
  v_mfma_f32_16x16x32_bf16 v[64:67], v[8:11], a[248:251], v[64:67]
  v_mfma_f32_16x16x32_bf16 v[68:71], v[12:15], a[248:251], v[68:71]
  s_waitcnt lgkmcnt(0)
  v_mfma_f32_16x16x32_bf16 v[24:27], v[244:247], v[16:19], v[24:27]
  v_mfma_f32_16x16x32_bf16 v[28:31], v[244:247], v[20:23], v[28:31]
  v_mfma_f32_16x16x32_bf16 v[32:35], v[252:255], v[16:19], v[32:35]
  v_mfma_f32_16x16x32_bf16 v[36:39], v[252:255], v[20:23], v[36:39]
  v_mfma_f32_16x16x32_bf16 v[40:43], a[116:119], v[16:19], v[40:43]
  v_mfma_f32_16x16x32_bf16 v[44:47], a[116:119], v[20:23], v[44:47]
  v_mfma_f32_16x16x32_bf16 v[48:51], a[124:127], v[16:19], v[48:51]
  v_mfma_f32_16x16x32_bf16 v[52:55], a[124:127], v[20:23], v[52:55]
  v_mfma_f32_16x16x32_bf16 v[56:59], v[16:19], a[244:247], v[56:59]
  v_mfma_f32_16x16x32_bf16 v[60:63], v[20:23], a[244:247], v[60:63]
  v_mfma_f32_16x16x32_bf16 v[64:67], v[16:19], a[252:255], v[64:67]
  v_mfma_f32_16x16x32_bf16 v[68:71], v[20:23], a[252:255], v[68:71]
  s_lshl_b32 s36, s33, 6
  s_add_u32 s36, s36, s40
  s_lshl_b32 s37, s36, 14
  s_lshl_b32 s36, s36, 13
  s_lshl_b32 s38, s32, 10
  s_add_u32 s36, s36, s38
  s_add_u32 s36, s36, 16777216
  s_add_u32 s46, s36, 4096
  s_add_u32 s39, s37, s38
  s_add_u32 s39, s39, 33554432
  s_add_u32 s47, s39, 4096
  s_add_u32 s37, s39, s38
  s_add_u32 s37, s37, 8192
  v_mul_f32 v24, s68, v24
  v_mul_f32 v25, s68, v25
  v_mul_f32 v26, s68, v26
  v_mul_f32 v27, s68, v27
  v_mul_f32 v32, s68, v32
  v_mul_f32 v33, s68, v33
  v_mul_f32 v34, s68, v34
  v_mul_f32 v35, s68, v35
  v_cvt_pk_bf16_f32 v72, v24, v25
  v_cvt_pk_bf16_f32 v73, v26, v27
  v_cvt_pk_bf16_f32 v74, v32, v33
  v_cvt_pk_bf16_f32 v75, v34, v35
  buffer_store_dwordx4 v[72:75], v0, s[8:11], s36 offen sc1
  v_mul_f32 v28, s68, v28
  v_mul_f32 v29, s68, v29
  v_mul_f32 v30, s68, v30
  v_mul_f32 v31, s68, v31
  v_mul_f32 v36, s68, v36
  v_mul_f32 v37, s68, v37
  v_mul_f32 v38, s68, v38
  v_mul_f32 v39, s68, v39
  v_cvt_pk_bf16_f32 v76, v28, v29
  v_cvt_pk_bf16_f32 v77, v30, v31
  v_cvt_pk_bf16_f32 v78, v36, v37
  v_cvt_pk_bf16_f32 v79, v38, v39
  buffer_store_dwordx4 v[76:79], v0, s[8:11], s46 offen sc1
  v_cvt_pk_bf16_f32 v80, v40, v41
  v_cvt_pk_bf16_f32 v81, v42, v43
  v_cvt_pk_bf16_f32 v82, v48, v49
  v_cvt_pk_bf16_f32 v83, v50, v51
  buffer_store_dwordx4 v[80:83], v0, s[8:11], s39 offen sc1
  v_cvt_pk_bf16_f32 v84, v44, v45
  v_cvt_pk_bf16_f32 v85, v46, v47
  v_cvt_pk_bf16_f32 v86, v52, v53
  v_cvt_pk_bf16_f32 v87, v54, v55
  buffer_store_dwordx4 v[84:87], v0, s[8:11], s47 offen sc1
  v_cvt_pk_bf16_f32 v88, v56, v57
  v_cvt_pk_bf16_f32 v89, v58, v59
  v_cvt_pk_bf16_f32 v90, v60, v61
  v_cvt_pk_bf16_f32 v91, v62, v63
  buffer_store_dwordx4 v[88:91], v0, s[8:11], s37 offen offset:0 sc1
  v_cvt_pk_bf16_f32 v92, v64, v65
  v_cvt_pk_bf16_f32 v93, v66, v67
  v_cvt_pk_bf16_f32 v94, v68, v69
  v_cvt_pk_bf16_f32 v95, v70, v71
  buffer_store_dwordx4 v[92:95], v0, s[8:11], s37 offen offset:1024 sc1
  s_cmp_lt_u32 s40, 58
  s_cbranch_scc1 qkv_nosent
  s_lshl_b32 s36, s40, 18
  s_lshl_b32 s37, s33, 12
  s_add_u32 s36, s36, s37
  s_add_u32 s36, s36, s38
  s_add_u32 s36, s36, 67108864
  s_add_u32 s37, s36, 0x20000
  buffer_store_dwordx4 v[96:99], v0, s[8:11], s36 offen sc1
  buffer_store_dwordx4 v[96:99], v0, s[8:11], s37 offen sc1
qkv_nosent:
  s_mov_b32 s44, s40
qkv_next:
  v_xor_b32 v4, 0x8000, v4
  s_mov_b32 s40, s41
  s_cmp_lt_u32 s40, 64
  s_cbranch_scc1 qkv_top
  s_waitcnt vmcnt(0)
  s_lshl_b32 s36, s33, 8
  s_lshl_b32 s37, s44, 2
  s_add_u32 s36, s36, s37
  s_mov_b64 exec, 1
  v_mov_b32 v6, 1
  v_mov_b32 v7, 0
  buffer_atomic_add v6, v7, s[8:11], s36 offen sc1
  s_mov_b64 exec, -1
qkv_end:
  s_barrier
  s_cmp_lt_u32 s89, 4
  s_cbranch_scc1 L_gu
  s_sub_u32 s40, s89, 4
  v_and_b32 v21, 8, v1
  v_cmp_eq_u32 vcc, 0, v21
  v_mov_b32 v22, 0xeeee
  v_mov_b32 v23, 0x4444
  v_cndmask_b32 v4, v22, v23, vcc
  v_lshrrev_b32 v21, 5, v1
  v_and_b32 v22, 15, v1
  v_lshl_add_u32 v21, v21, 4, v22
  v_lshlrev_b32 v21, 4, v21
  v_bfe_u32 v22, v1, 4, 1
  v_lshl_add_u32 v21, v22, 3, v21
  s_lshl_b32 s38, s32, 9
  v_add_u32 v5, s38, v21
  v_lshrrev_b32 v21, 2, v1
  v_lshlrev_b32 v21, 4, v21
  v_and_b32 v22, 1, v1
  v_lshl_add_u32 v6, v22, 3, v21
  s_lshl_b32 s53, s32, 11
  v_add_u32 v7, s53, v0
  s_mov_b32 s68, 1040356334
  v_mov_b32 v188, 0x3f803f80
  v_mov_b32 v189, 0x3f803f80
  v_mov_b32 v190, 0x3f803f80
  v_mov_b32 v191, 0x3f803f80
  s_mov_b32 s82, -1
  s_mov_b32 s83, 0
  v_cndmask_b32 v192, 0, v188, s[82:83]
  v_cndmask_b32 v193, 0, v188, s[82:83]
  v_mov_b32 v194, 0xff800000
  v_mov_b32 v174, 0
  v_mov_b32 v175, 0
  v_lshrrev_b32 v21, 4, v1
  v_lshlrev_b32 v21, 2, v21
  v_and_b32 v22, 15, v1
  v_add_u32 v23, 0, v21
  v_cmp_le_u32 s[72:73], v23, v22
  v_add_u32 v23, 1, v21
  v_cmp_le_u32 s[74:75], v23, v22
  v_add_u32 v23, 2, v21
  v_cmp_le_u32 s[76:77], v23, v22
  v_add_u32 v23, 3, v21
  v_cmp_le_u32 s[78:79], v23, v22
  s_mov_b64 s[70:71], 0
  s_mov_b32 s48, -1
att_top:
  s_mov_b32 s41, s40
  s_min_u32 s41, s41, 63
att_r0:
  s_bitcmp1_b64 s[70:71], s41
  s_cbranch_scc1 att_r0_ok
  v_lshlrev_b32 v14, 2, v1
  s_lshl_b32 s37, s33, 8
  buffer_load_dword v15, v14, s[8:11], s37 offen sc1
  s_waitcnt vmcnt(0)
  v_cmp_le_u32 s[70:71], 4, v15
  s_sub_u32 s35, s35, 1
  s_cbranch_scc0 att_r0
  s_mov_b32 s35, 0
att_r0_ok:
  s_lshl_b32 s42, s33, 6
  s_add_u32 s42, s42, s41
  s_lshl_b32 s43, s42, 14
  s_lshl_b32 s42, s42, 13
  s_add_u32 s42, s42, 16777216
  s_add_u32 s44, s42, 4096
  s_add_u32 s43, s43, 33554432
  s_add_u32 s45, s43, 4096
  s_add_u32 s46, s43, 8192
  s_lshl_b32 s47, s41, 13
  s_add_u32 s47, s47, 524288
  buffer_load_dwordx4 v[64:67], v0, s[8:11], s43 offen offset:0 sc1
  buffer_load_dwordx4 v[68:71], v0, s[8:11], s43 offen offset:1024 sc1
  buffer_load_dwordx4 v[72:75], v0, s[8:11], s43 offen offset:2048 sc1
  buffer_load_dwordx4 v[76:79], v0, s[8:11], s43 offen offset:3072 sc1
  buffer_load_dwordx4 v[80:83], v0, s[8:11], s45 offen offset:0 sc1
  buffer_load_dwordx4 v[84:87], v0, s[8:11], s45 offen offset:1024 sc1
  buffer_load_dwordx4 v[88:91], v0, s[8:11], s45 offen offset:2048 sc1
  buffer_load_dwordx4 v[92:95], v0, s[8:11], s45 offen offset:3072 sc1
  buffer_load_dwordx4 v[96:99], v0, s[8:11], s42 offen offset:0 sc1
  buffer_load_dwordx4 v[100:103], v0, s[8:11], s42 offen offset:1024 sc1
  buffer_load_dwordx4 v[104:107], v0, s[8:11], s42 offen offset:2048 sc1
  buffer_load_dwordx4 v[108:111], v0, s[8:11], s42 offen offset:3072 sc1
  buffer_load_dwordx4 v[112:115], v0, s[8:11], s44 offen offset:0 sc1
  buffer_load_dwordx4 v[116:119], v0, s[8:11], s44 offen offset:1024 sc1
  buffer_load_dwordx4 v[120:123], v0, s[8:11], s44 offen offset:2048 sc1
  buffer_load_dwordx4 v[124:127], v0, s[8:11], s44 offen offset:3072 sc1
  buffer_load_dwordx4 v[128:131], v7, s[8:11], s46 offen offset:0 sc1
  buffer_load_dwordx4 v[132:135], v7, s[8:11], s46 offen offset:1024 sc1
  buffer_load_dwordx4 v[16:19], v7, s[8:11], s47 offen offset:0 sc1
  buffer_load_dwordx4 v[20:23], v7, s[8:11], s47 offen offset:1024 sc1
  v_mov_b64 v[48:49], 0
  v_mov_b64 v[50:51], 0
  v_mov_b64 v[52:53], 0
  v_mov_b64 v[54:55], 0
  v_mov_b64 v[56:57], 0
  v_mov_b64 v[58:59], 0
  v_mov_b64 v[60:61], 0
  v_mov_b64 v[62:63], 0
  s_waitcnt vmcnt(0)
  v_mfma_f32_16x16x32_bf16 v[156:159], v[64:67], v[96:99], 0
  v_mfma_f32_16x16x32_bf16 v[164:167], v[64:67], v[112:115], 0
  v_mfma_f32_16x16x32_bf16 v[168:171], v[80:83], v[112:115], 0
  v_mfma_f32_16x16x32_bf16 v[156:159], v[68:71], v[100:103], v[156:159]
  v_mfma_f32_16x16x32_bf16 v[164:167], v[68:71], v[116:119], v[164:167]
  v_mfma_f32_16x16x32_bf16 v[168:171], v[84:87], v[116:119], v[168:171]
  v_mfma_f32_16x16x32_bf16 v[156:159], v[72:75], v[104:107], v[156:159]
  v_mfma_f32_16x16x32_bf16 v[164:167], v[72:75], v[120:123], v[164:167]
  v_mfma_f32_16x16x32_bf16 v[168:171], v[88:91], v[120:123], v[168:171]
  v_mfma_f32_16x16x32_bf16 v[156:159], v[76:79], v[108:111], v[156:159]
  v_mfma_f32_16x16x32_bf16 v[164:167], v[76:79], v[124:127], v[164:167]
  v_mfma_f32_16x16x32_bf16 v[168:171], v[92:95], v[124:127], v[168:171]
att_chk:
  v_max3_u32 v8, v16, v17, v18
  v_max3_u32 v8, v8, v19, v20
  v_max3_u32 v8, v8, v21, v22
  v_max_u32 v8, v8, v23
  v_cmp_eq_u32 vcc, -1, v8
  s_cbranch_vccz att_ok
  s_sleep 3
  buffer_load_dwordx4 v[16:19], v7, s[8:11], s47 offen offset:0 sc1
  buffer_load_dwordx4 v[20:23], v7, s[8:11], s47 offen offset:1024 sc1
  s_waitcnt vmcnt(0)
  s_sub_u32 s35, s35, 1
  s_cbranch_scc0 att_chk
  s_mov_b32 s35, 0
att_ok:
  ds_write_b128 v7, v[16:19] offset:0
  ds_write_b128 v7, v[20:23] offset:1024
  s_waitcnt lgkmcnt(0)
  s_barrier
  ds_read_b128 v[16:19], v0 offset:0
  ds_read_b128 v[20:23], v0 offset:1024
  ds_read_b128 v[24:27], v0 offset:2048
  ds_read_b128 v[28:31], v0 offset:3072
  ds_read_b128 v[32:35], v0 offset:4096
  ds_read_b128 v[36:39], v0 offset:5120
  ds_read_b128 v[40:43], v0 offset:6144
  ds_read_b128 v[44:47], v0 offset:7168
  s_waitcnt lgkmcnt(7)
  v_smfmac_f32_16x16x64_bf16 v[48:51], v[16:19], a[0:7], v4
  v_smfmac_f32_16x16x64_bf16 v[52:55], v[16:19], a[8:15], v4
  s_waitcnt lgkmcnt(6)
  v_smfmac_f32_16x16x64_bf16 v[48:51], v[20:23], a[16:23], v4
  v_smfmac_f32_16x16x64_bf16 v[52:55], v[20:23], a[24:31], v4
  s_waitcnt lgkmcnt(5)
  v_smfmac_f32_16x16x64_bf16 v[48:51], v[24:27], a[32:39], v4
  v_smfmac_f32_16x16x64_bf16 v[52:55], v[24:27], a[40:47], v4
  s_waitcnt lgkmcnt(4)
  v_smfmac_f32_16x16x64_bf16 v[48:51], v[28:31], a[48:55], v4
  v_smfmac_f32_16x16x64_bf16 v[52:55], v[28:31], a[56:63], v4
  s_waitcnt lgkmcnt(3)
  v_smfmac_f32_16x16x64_bf16 v[48:51], v[32:35], a[64:71], v4
  v_smfmac_f32_16x16x64_bf16 v[52:55], v[32:35], a[72:79], v4
  s_waitcnt lgkmcnt(2)
  v_smfmac_f32_16x16x64_bf16 v[48:51], v[36:39], a[80:87], v4
  v_smfmac_f32_16x16x64_bf16 v[52:55], v[36:39], a[88:95], v4
  s_waitcnt lgkmcnt(1)
  v_smfmac_f32_16x16x64_bf16 v[48:51], v[40:43], a[96:103], v4
  v_smfmac_f32_16x16x64_bf16 v[52:55], v[40:43], a[104:111], v4
  s_waitcnt lgkmcnt(0)
  v_smfmac_f32_16x16x64_bf16 v[48:51], v[44:47], a[112:119], v4
  v_smfmac_f32_16x16x64_bf16 v[52:55], v[44:47], a[120:127], v4
  s_cmp_ge_u32 s48, 58
  s_cbranch_scc1 att_nf
  s_cmp_lg_u32 s32, 0
  s_cbranch_scc1 att_nf
  s_lshl_b32 s36, s48, 7
  s_add_u32 s36, s36, 24576
  s_mov_b64 exec, 1
  v_mov_b32 v14, 1
  v_mov_b32 v15, 0
  buffer_atomic_add v14, v15, s[8:11], s36 offen sc1
  s_mov_b64 exec, -1
att_nf:
  v_smfmac_f32_16x16x64_bf16 v[56:59], v[16:19], a[128:135], v4
  v_smfmac_f32_16x16x64_bf16 v[60:63], v[16:19], a[136:143], v4
  v_smfmac_f32_16x16x64_bf16 v[56:59], v[20:23], a[144:151], v4
  v_permlane32_swap_b32 v48, v52
  v_permlane32_swap_b32 v49, v53
  v_smfmac_f32_16x16x64_bf16 v[60:63], v[20:23], a[152:159], v4
  v_permlane32_swap_b32 v50, v54
  v_permlane32_swap_b32 v51, v55
  v_smfmac_f32_16x16x64_bf16 v[56:59], v[24:27], a[160:167], v4
  v_add_f32 v48, v48, v52
  v_add_f32 v49, v49, v53
  v_smfmac_f32_16x16x64_bf16 v[60:63], v[24:27], a[168:175], v4
  v_add_f32 v50, v50, v54
  v_add_f32 v51, v51, v55
  v_smfmac_f32_16x16x64_bf16 v[56:59], v[28:31], a[176:183], v4
  v_cvt_pk_bf16_f32 v8, v48, v49
  v_cvt_pk_bf16_f32 v9, v50, v51
  v_smfmac_f32_16x16x64_bf16 v[60:63], v[28:31], a[184:191], v4
  ds_write_b64 v5, v[8:9] offset:8192
  v_smfmac_f32_16x16x64_bf16 v[56:59], v[32:35], a[192:199], v4
  v_smfmac_f32_16x16x64_bf16 v[60:63], v[32:35], a[200:207], v4
  v_smfmac_f32_16x16x64_bf16 v[56:59], v[36:39], a[208:215], v4
  v_smfmac_f32_16x16x64_bf16 v[60:63], v[36:39], a[216:223], v4
  s_waitcnt lgkmcnt(0)
  s_barrier
  v_smfmac_f32_16x16x64_bf16 v[56:59], v[40:43], a[224:231], v4
  ds_read_b64_tr_b16 v[136:137], v6 offset:8192
  ds_read_b64_tr_b16 v[138:139], v6 offset:8448
  v_smfmac_f32_16x16x64_bf16 v[60:63], v[40:43], a[232:239], v4
  ds_read_b64_tr_b16 v[140:141], v6 offset:8704
  ds_read_b64_tr_b16 v[142:143], v6 offset:8960
  v_smfmac_f32_16x16x64_bf16 v[56:59], v[44:47], a[240:247], v4
  ds_read_b64_tr_b16 v[144:145], v6 offset:9216
  ds_read_b64_tr_b16 v[146:147], v6 offset:9472
  v_smfmac_f32_16x16x64_bf16 v[60:63], v[44:47], a[248:255], v4
  ds_read_b64_tr_b16 v[148:149], v6 offset:9728
  ds_read_b64_tr_b16 v[150:151], v6 offset:9984
  v_cndmask_b32 v156, v194, v156, s[72:73]
  v_cndmask_b32 v157, v194, v157, s[74:75]
  v_cndmask_b32 v158, v194, v158, s[76:77]
  v_cndmask_b32 v159, v194, v159, s[78:79]
  v_cndmask_b32 v168, v194, v168, s[72:73]
  v_cndmask_b32 v169, v194, v169, s[74:75]
  v_cndmask_b32 v170, v194, v170, s[76:77]
  v_cndmask_b32 v171, v194, v171, s[78:79]
  s_waitcnt lgkmcnt(6)
  v_mfma_f32_16x16x32_bf16 v[152:155], v[136:139], v[96:99], 0
  v_mfma_f32_16x16x32_bf16 v[160:163], v[136:139], v[112:115], 0
  s_waitcnt lgkmcnt(4)
  v_mfma_f32_16x16x32_bf16 v[152:155], v[140:143], v[100:103], v[152:155]
  v_mfma_f32_16x16x32_bf16 v[160:163], v[140:143], v[116:119], v[160:163]
  s_waitcnt lgkmcnt(2)
  v_mfma_f32_16x16x32_bf16 v[152:155], v[144:147], v[104:107], v[152:155]
  v_mfma_f32_16x16x32_bf16 v[160:163], v[144:147], v[120:123], v[160:163]
  s_waitcnt lgkmcnt(0)
  v_mfma_f32_16x16x32_bf16 v[152:155], v[148:151], v[108:111], v[152:155]
  v_mfma_f32_16x16x32_bf16 v[160:163], v[148:151], v[124:127], v[160:163]
  v_cvt_pk_bf16_f32 v184, v56, v57
  v_cvt_pk_bf16_f32 v185, v58, v59
  v_cvt_pk_bf16_f32 v186, v60, v61
  v_cvt_pk_bf16_f32 v187, v62, v63
  s_lshl_b32 s36, s40, 18
  s_lshl_b32 s37, s33, 12
  s_add_u32 s36, s36, s37
  s_lshl_b32 s37, s32, 10
  s_add_u32 s36, s36, s37
  s_add_u32 s36, s36, 67108864
  s_add_u32 s37, s36, 0x20000
  v_max3_f32 v8, v152, v153, v154
  v_max3_f32 v8, v8, v155, v156
  v_max3_f32 v8, v8, v157, v158
  v_max_f32 v8, v8, v159
  v_mov_b32 v9, v8
  s_nop 1
  v_permlane32_swap_b32 v8, v9
  v_max_f32 v8, v8, v9
  v_mov_b32 v9, v8
  s_nop 1
  v_permlane16_swap_b32 v8, v9
  v_max_f32 v8, v8, v9
  v_sub_f32 v152, v152, v8
  v_sub_f32 v153, v153, v8
  v_sub_f32 v154, v154, v8
  v_sub_f32 v155, v155, v8
  v_sub_f32 v156, v156, v8
  v_sub_f32 v157, v157, v8
  v_sub_f32 v158, v158, v8
  v_sub_f32 v159, v159, v8
  v_exp_f32 v152, v152
  v_exp_f32 v153, v153
  v_exp_f32 v154, v154
  v_exp_f32 v155, v155
  v_exp_f32 v156, v156
  v_exp_f32 v157, v157
  v_exp_f32 v158, v158
  v_exp_f32 v159, v159
  v_cvt_pk_bf16_f32 v180, v152, v153
  v_cvt_pk_bf16_f32 v181, v154, v155
  v_cvt_pk_bf16_f32 v172, v156, v157
  v_cvt_pk_bf16_f32 v173, v158, v159
  s_nop 1
  v_mfma_f32_16x16x32_bf16 v[196:199], v[188:191], v[172:175], 0
  v_mfma_f32_16x16x32_bf16 v[204:207], v[128:131], v[172:175], 0
  v_mfma_f32_16x16x32_bf16 v[208:211], v[132:135], v[172:175], 0
  s_nop 3
  v_mfma_f32_16x16x16_bf16 v[196:199], v[192:193], v[180:181], v[196:199]
  v_mfma_f32_16x16x16_bf16 v[204:207], v[184:185], v[180:181], v[204:207]
  v_mfma_f32_16x16x16_bf16 v[208:211], v[186:187], v[180:181], v[208:211]
  v_max3_f32 v10, v160, v161, v162
  v_max3_f32 v10, v10, v163, v164
  v_max3_f32 v10, v10, v165, v166
  v_max3_f32 v10, v10, v167, v168
  v_max3_f32 v10, v10, v169, v170
  v_max_f32 v10, v10, v171
  v_mov_b32 v11, v10
  s_nop 1
  v_permlane32_swap_b32 v10, v11
  v_max_f32 v10, v10, v11
  v_mov_b32 v11, v10
  s_nop 1
  v_permlane16_swap_b32 v10, v11
  v_max_f32 v10, v10, v11
  v_sub_f32 v160, v160, v10
  v_sub_f32 v161, v161, v10
  v_sub_f32 v162, v162, v10
  v_sub_f32 v163, v163, v10
  v_sub_f32 v164, v164, v10
  v_sub_f32 v165, v165, v10
  v_sub_f32 v166, v166, v10
  v_sub_f32 v167, v167, v10
  v_sub_f32 v168, v168, v10
  v_sub_f32 v169, v169, v10
  v_sub_f32 v170, v170, v10
  v_sub_f32 v171, v171, v10
  v_exp_f32 v160, v160
  v_exp_f32 v161, v161
  v_exp_f32 v162, v162
  v_exp_f32 v163, v163
  v_exp_f32 v164, v164
  v_exp_f32 v165, v165
  v_exp_f32 v166, v166
  v_exp_f32 v167, v167
  v_exp_f32 v168, v168
  v_exp_f32 v169, v169
  v_exp_f32 v170, v170
  v_exp_f32 v171, v171
  v_cvt_pk_bf16_f32 v182, v160, v161
  v_cvt_pk_bf16_f32 v183, v162, v163
  v_cvt_pk_bf16_f32 v176, v164, v165
  v_cvt_pk_bf16_f32 v177, v166, v167
  v_cvt_pk_bf16_f32 v178, v168, v169
  v_cvt_pk_bf16_f32 v179, v170, v171
  s_nop 1
  v_mfma_f32_16x16x32_bf16 v[200:203], v[188:191], v[176:179], 0
  v_mfma_f32_16x16x32_bf16 v[212:215], v[128:131], v[176:179], 0
  v_mfma_f32_16x16x32_bf16 v[216:219], v[132:135], v[176:179], 0
  s_nop 3
  v_mfma_f32_16x16x16_bf16 v[200:203], v[192:193], v[182:183], v[200:203]
  v_mfma_f32_16x16x16_bf16 v[212:215], v[184:185], v[182:183], v[212:215]
  v_mfma_f32_16x16x16_bf16 v[216:219], v[186:187], v[182:183], v[216:219]
  v_rcp_f32 v12, v196
  s_nop 0
  v_mul_f32 v204, v204, v12
  v_mul_f32 v205, v205, v12
  v_mul_f32 v206, v206, v12
  v_mul_f32 v207, v207, v12
  v_cvt_pk_bf16_f32 v220, v204, v205
  v_cvt_pk_bf16_f32 v221, v206, v207
  v_mul_f32 v208, v208, v12
  v_mul_f32 v209, v209, v12
  v_mul_f32 v210, v210, v12
  v_mul_f32 v211, v211, v12
  v_cvt_pk_bf16_f32 v222, v208, v209
  v_cvt_pk_bf16_f32 v223, v210, v211
  buffer_store_dwordx4 v[220:223], v0, s[8:11], s36 offen sc1
  v_rcp_f32 v12, v200
  s_nop 0
  v_mul_f32 v212, v212, v12
  v_mul_f32 v213, v213, v12
  v_mul_f32 v214, v214, v12
  v_mul_f32 v215, v215, v12
  v_cvt_pk_bf16_f32 v224, v212, v213
  v_cvt_pk_bf16_f32 v225, v214, v215
  v_mul_f32 v216, v216, v12
  v_mul_f32 v217, v217, v12
  v_mul_f32 v218, v218, v12
  v_mul_f32 v219, v219, v12
  v_cvt_pk_bf16_f32 v226, v216, v217
  v_cvt_pk_bf16_f32 v227, v218, v219
  buffer_store_dwordx4 v[224:227], v0, s[8:11], s37 offen sc1
  s_mov_b32 s48, s40
  s_add_u32 s40, s40, 2
  s_cmp_lt_u32 s40, 64
  s_cbranch_scc1 att_top
  s_endpgm
L_gu:
  s_lshl_b32 s90, s33, 2
  s_add_u32 s90, s90, s89
  s_cmp_ge_u32 s90, 121
  s_cbranch_scc1 L_out
  s_mul_i32 s40, s90, 5958
  s_lshr_b32 s40, s40, 16
  s_mul_i32 s36, s40, 11
  s_sub_u32 s48, s90, s36
  s_load_dwordx4 s[16:19], s[0:1], 64
  s_waitcnt lgkmcnt(0)
  s_mov_b32 s20, s18
  s_and_b32 s21, s19, 0xffff
  s_mov_b32 s22, 1409024
  s_mov_b32 s23, 0x20000
  s_and_b32 s17, s17, 0xffff
  s_mov_b32 s18, 1409024
  s_mov_b32 s19, 0x20000
  s_lshl_b32 s49, s48, 2
  s_add_u32 s49, s49, s32
  s_cmp_lt_u32 s49, 43
  s_cselect_b32 s50, 1, 0
  s_min_u32 s49, s49, 42
  s_lshl_b32 s45, s49, 6
  v_bfe_u32 v21, v1, 4, 1
  v_bfe_u32 v22, v1, 3, 1
  v_bfe_u32 v23, v1, 2, 1
  v_bfe_u32 v24, v1, 1, 1
  v_and_b32 v25, 1, v1
  v_lshrrev_b32 v26, 5, v1
  v_lshlrev_b32 v27, 3, v21
  v_lshl_add_u32 v27, v22, 1, v27
  v_lshl_add_u32 v27, v23, 2, v27
  v_lshl_add_u32 v27, v24, 5, v27
  v_mul_u32_u24 v27, 2752, v27
  v_lshl_add_u32 v27, v26, 5, v27
  v_lshl_add_u32 v3, v25, 4, v27
  s_add_u32 m0, s52, 0
  s_add_u32 s38, s45, 0
  buffer_load_dwordx4 v3, s[16:19], s38 offen lds
  s_add_u32 m0, s52, 1024
  s_add_u32 s38, s45, 2752
  buffer_load_dwordx4 v3, s[16:19], s38 offen lds
  s_add_u32 m0, s52, 2048
  s_add_u32 s38, s45, 44032
  buffer_load_dwordx4 v3, s[16:19], s38 offen lds
  s_add_u32 m0, s52, 3072
  s_add_u32 s38, s45, 46784
  buffer_load_dwordx4 v3, s[16:19], s38 offen lds
  s_add_u32 m0, s52, 4096
  s_add_u32 s38, s45, 0
  buffer_load_dwordx4 v3, s[20:23], s38 offen lds
  s_add_u32 m0, s52, 5120
  s_add_u32 s38, s45, 2752
  buffer_load_dwordx4 v3, s[20:23], s38 offen lds
  s_add_u32 m0, s52, 6144
  s_add_u32 s38, s45, 44032
  buffer_load_dwordx4 v3, s[20:23], s38 offen lds
  s_add_u32 m0, s52, 7168
  s_add_u32 s38, s45, 46784
  buffer_load_dwordx4 v3, s[20:23], s38 offen lds
  s_add_u32 m0, s52, 8192
  s_add_u32 s38, s45, 176128
  buffer_load_dwordx4 v3, s[16:19], s38 offen lds
  s_add_u32 m0, s52, 9216
  s_add_u32 s38, s45, 178880
  buffer_load_dwordx4 v3, s[16:19], s38 offen lds
  s_add_u32 m0, s52, 10240
  s_add_u32 s38, s45, 220160
  buffer_load_dwordx4 v3, s[16:19], s38 offen lds
  s_add_u32 m0, s52, 11264
  s_add_u32 s38, s45, 222912
  buffer_load_dwordx4 v3, s[16:19], s38 offen lds
  s_add_u32 m0, s52, 12288
  s_add_u32 s38, s45, 176128
  buffer_load_dwordx4 v3, s[20:23], s38 offen lds
  s_add_u32 m0, s52, 13312
  s_add_u32 s38, s45, 178880
  buffer_load_dwordx4 v3, s[20:23], s38 offen lds
  s_add_u32 m0, s52, 14336
  s_add_u32 s38, s45, 220160
  buffer_load_dwordx4 v3, s[20:23], s38 offen lds
  s_add_u32 m0, s52, 15360
  s_add_u32 s38, s45, 222912
  buffer_load_dwordx4 v3, s[20:23], s38 offen lds
  s_add_u32 m0, s52, 16384
  s_add_u32 s38, s45, 352256
  buffer_load_dwordx4 v3, s[16:19], s38 offen lds
  s_add_u32 m0, s52, 17408
  s_add_u32 s38, s45, 355008
  buffer_load_dwordx4 v3, s[16:19], s38 offen lds
  s_add_u32 m0, s52, 18432
  s_add_u32 s38, s45, 396288
  buffer_load_dwordx4 v3, s[16:19], s38 offen lds
  s_add_u32 m0, s52, 19456
  s_add_u32 s38, s45, 399040
  buffer_load_dwordx4 v3, s[16:19], s38 offen lds
  s_add_u32 m0, s52, 20480
  s_add_u32 s38, s45, 352256
  buffer_load_dwordx4 v3, s[20:23], s38 offen lds
  s_add_u32 m0, s52, 21504
  s_add_u32 s38, s45, 355008
  buffer_load_dwordx4 v3, s[20:23], s38 offen lds
  s_add_u32 m0, s52, 22528
  s_add_u32 s38, s45, 396288
  buffer_load_dwordx4 v3, s[20:23], s38 offen lds
  s_add_u32 m0, s52, 23552
  s_add_u32 s38, s45, 399040
  buffer_load_dwordx4 v3, s[20:23], s38 offen lds
  s_add_u32 m0, s52, 24576
  s_add_u32 s38, s45, 528384
  buffer_load_dwordx4 v3, s[16:19], s38 offen lds
  s_add_u32 m0, s52, 25600
  s_add_u32 s38, s45, 531136
  buffer_load_dwordx4 v3, s[16:19], s38 offen lds
  s_add_u32 m0, s52, 26624
  s_add_u32 s38, s45, 572416
  buffer_load_dwordx4 v3, s[16:19], s38 offen lds
  s_add_u32 m0, s52, 27648
  s_add_u32 s38, s45, 575168
  buffer_load_dwordx4 v3, s[16:19], s38 offen lds
  s_add_u32 m0, s52, 28672
  s_add_u32 s38, s45, 528384
  buffer_load_dwordx4 v3, s[20:23], s38 offen lds
  s_add_u32 m0, s52, 29696
  s_add_u32 s38, s45, 531136
  buffer_load_dwordx4 v3, s[20:23], s38 offen lds
  s_add_u32 m0, s52, 30720
  s_add_u32 s38, s45, 572416
  buffer_load_dwordx4 v3, s[20:23], s38 offen lds
  s_add_u32 m0, s52, 31744
  s_add_u32 s38, s45, 575168
  buffer_load_dwordx4 v3, s[20:23], s38 offen lds
  s_waitcnt vmcnt(28)
  ds_read_b64_tr_b16 a[0:1], v2 offset:0
  ds_read_b64_tr_b16 a[2:3], v2 offset:1024
  ds_read_b64_tr_b16 a[4:5], v2 offset:2048
  ds_read_b64_tr_b16 a[6:7], v2 offset:3072
  ds_read_b64_tr_b16 a[8:9], v2 offset:512
  ds_read_b64_tr_b16 a[10:11], v2 offset:1536
  ds_read_b64_tr_b16 a[12:13], v2 offset:2560
  ds_read_b64_tr_b16 a[14:15], v2 offset:3584
  s_waitcnt lgkmcnt(8)
  s_add_u32 m0, s52, 32768
  s_add_u32 s38, s45, 704512
  buffer_load_dwordx4 v3, s[16:19], s38 offen lds
  s_add_u32 m0, s52, 33792
  s_add_u32 s38, s45, 707264
  buffer_load_dwordx4 v3, s[16:19], s38 offen lds
  s_add_u32 m0, s52, 34816
  s_add_u32 s38, s45, 748544
  buffer_load_dwordx4 v3, s[16:19], s38 offen lds
  s_add_u32 m0, s52, 35840
  s_add_u32 s38, s45, 751296
  buffer_load_dwordx4 v3, s[16:19], s38 offen lds
  s_waitcnt vmcnt(28)
  ds_read_b64_tr_b16 a[128:129], v2 offset:4096
  ds_read_b64_tr_b16 a[130:131], v2 offset:5120
  ds_read_b64_tr_b16 a[132:133], v2 offset:6144
  ds_read_b64_tr_b16 a[134:135], v2 offset:7168
  ds_read_b64_tr_b16 a[136:137], v2 offset:4608
  ds_read_b64_tr_b16 a[138:139], v2 offset:5632
  ds_read_b64_tr_b16 a[140:141], v2 offset:6656
  ds_read_b64_tr_b16 a[142:143], v2 offset:7680
  s_waitcnt lgkmcnt(8)
  s_add_u32 m0, s52, 0
  s_add_u32 s38, s45, 704512
  buffer_load_dwordx4 v3, s[20:23], s38 offen lds
  s_add_u32 m0, s52, 1024
  s_add_u32 s38, s45, 707264
  buffer_load_dwordx4 v3, s[20:23], s38 offen lds
  s_add_u32 m0, s52, 2048
  s_add_u32 s38, s45, 748544
  buffer_load_dwordx4 v3, s[20:23], s38 offen lds
  s_add_u32 m0, s52, 3072
  s_add_u32 s38, s45, 751296
  buffer_load_dwordx4 v3, s[20:23], s38 offen lds
  s_waitcnt vmcnt(28)
  ds_read_b64_tr_b16 a[16:17], v2 offset:8192
  ds_read_b64_tr_b16 a[18:19], v2 offset:9216
  ds_read_b64_tr_b16 a[20:21], v2 offset:10240
  ds_read_b64_tr_b16 a[22:23], v2 offset:11264
  ds_read_b64_tr_b16 a[24:25], v2 offset:8704
  ds_read_b64_tr_b16 a[26:27], v2 offset:9728
  ds_read_b64_tr_b16 a[28:29], v2 offset:10752
  ds_read_b64_tr_b16 a[30:31], v2 offset:11776
  s_waitcnt lgkmcnt(8)
  s_add_u32 m0, s52, 4096
  s_add_u32 s38, s45, 880640
  buffer_load_dwordx4 v3, s[16:19], s38 offen lds
  s_add_u32 m0, s52, 5120
  s_add_u32 s38, s45, 883392
  buffer_load_dwordx4 v3, s[16:19], s38 offen lds
  s_add_u32 m0, s52, 6144
  s_add_u32 s38, s45, 924672
  buffer_load_dwordx4 v3, s[16:19], s38 offen lds
  s_add_u32 m0, s52, 7168
  s_add_u32 s38, s45, 927424
  buffer_load_dwordx4 v3, s[16:19], s38 offen lds
  s_waitcnt vmcnt(28)
  ds_read_b64_tr_b16 a[144:145], v2 offset:12288
  ds_read_b64_tr_b16 a[146:147], v2 offset:13312
  ds_read_b64_tr_b16 a[148:149], v2 offset:14336
  ds_read_b64_tr_b16 a[150:151], v2 offset:15360
  ds_read_b64_tr_b16 a[152:153], v2 offset:12800
  ds_read_b64_tr_b16 a[154:155], v2 offset:13824
  ds_read_b64_tr_b16 a[156:157], v2 offset:14848
  ds_read_b64_tr_b16 a[158:159], v2 offset:15872
  s_waitcnt lgkmcnt(8)
  s_add_u32 m0, s52, 8192
  s_add_u32 s38, s45, 880640
  buffer_load_dwordx4 v3, s[20:23], s38 offen lds
  s_add_u32 m0, s52, 9216
  s_add_u32 s38, s45, 883392
  buffer_load_dwordx4 v3, s[20:23], s38 offen lds
  s_add_u32 m0, s52, 10240
  s_add_u32 s38, s45, 924672
  buffer_load_dwordx4 v3, s[20:23], s38 offen lds
  s_add_u32 m0, s52, 11264
  s_add_u32 s38, s45, 927424
  buffer_load_dwordx4 v3, s[20:23], s38 offen lds
  s_waitcnt vmcnt(28)
  ds_read_b64_tr_b16 a[32:33], v2 offset:16384
  ds_read_b64_tr_b16 a[34:35], v2 offset:17408
  ds_read_b64_tr_b16 a[36:37], v2 offset:18432
  ds_read_b64_tr_b16 a[38:39], v2 offset:19456
  ds_read_b64_tr_b16 a[40:41], v2 offset:16896
  ds_read_b64_tr_b16 a[42:43], v2 offset:17920
  ds_read_b64_tr_b16 a[44:45], v2 offset:18944
  ds_read_b64_tr_b16 a[46:47], v2 offset:19968
  s_waitcnt lgkmcnt(8)
  s_add_u32 m0, s52, 12288
  s_add_u32 s38, s45, 1056768
  buffer_load_dwordx4 v3, s[16:19], s38 offen lds
  s_add_u32 m0, s52, 13312
  s_add_u32 s38, s45, 1059520
  buffer_load_dwordx4 v3, s[16:19], s38 offen lds
  s_add_u32 m0, s52, 14336
  s_add_u32 s38, s45, 1100800
  buffer_load_dwordx4 v3, s[16:19], s38 offen lds
  s_add_u32 m0, s52, 15360
  s_add_u32 s38, s45, 1103552
  buffer_load_dwordx4 v3, s[16:19], s38 offen lds
  s_waitcnt vmcnt(28)
  ds_read_b64_tr_b16 a[160:161], v2 offset:20480
  ds_read_b64_tr_b16 a[162:163], v2 offset:21504
  ds_read_b64_tr_b16 a[164:165], v2 offset:22528
  ds_read_b64_tr_b16 a[166:167], v2 offset:23552
  ds_read_b64_tr_b16 a[168:169], v2 offset:20992
  ds_read_b64_tr_b16 a[170:171], v2 offset:22016
  ds_read_b64_tr_b16 a[172:173], v2 offset:23040
  ds_read_b64_tr_b16 a[174:175], v2 offset:24064
  s_waitcnt lgkmcnt(8)
  s_add_u32 m0, s52, 16384
  s_add_u32 s38, s45, 1056768
  buffer_load_dwordx4 v3, s[20:23], s38 offen lds
  s_add_u32 m0, s52, 17408
  s_add_u32 s38, s45, 1059520
  buffer_load_dwordx4 v3, s[20:23], s38 offen lds
  s_add_u32 m0, s52, 18432
  s_add_u32 s38, s45, 1100800
  buffer_load_dwordx4 v3, s[20:23], s38 offen lds
  s_add_u32 m0, s52, 19456
  s_add_u32 s38, s45, 1103552
  buffer_load_dwordx4 v3, s[20:23], s38 offen lds
  s_waitcnt vmcnt(28)
  ds_read_b64_tr_b16 a[48:49], v2 offset:24576
  ds_read_b64_tr_b16 a[50:51], v2 offset:25600
  ds_read_b64_tr_b16 a[52:53], v2 offset:26624
  ds_read_b64_tr_b16 a[54:55], v2 offset:27648
  ds_read_b64_tr_b16 a[56:57], v2 offset:25088
  ds_read_b64_tr_b16 a[58:59], v2 offset:26112
  ds_read_b64_tr_b16 a[60:61], v2 offset:27136
  ds_read_b64_tr_b16 a[62:63], v2 offset:28160
  s_waitcnt lgkmcnt(8)
  s_add_u32 m0, s52, 20480
  s_add_u32 s38, s45, 1232896
  buffer_load_dwordx4 v3, s[16:19], s38 offen lds
  s_add_u32 m0, s52, 21504
  s_add_u32 s38, s45, 1235648
  buffer_load_dwordx4 v3, s[16:19], s38 offen lds
  s_add_u32 m0, s52, 22528
  s_add_u32 s38, s45, 1276928
  buffer_load_dwordx4 v3, s[16:19], s38 offen lds
  s_add_u32 m0, s52, 23552
  s_add_u32 s38, s45, 1279680
  buffer_load_dwordx4 v3, s[16:19], s38 offen lds
  s_waitcnt vmcnt(28)
  ds_read_b64_tr_b16 a[176:177], v2 offset:28672
  ds_read_b64_tr_b16 a[178:179], v2 offset:29696
  ds_read_b64_tr_b16 a[180:181], v2 offset:30720
  ds_read_b64_tr_b16 a[182:183], v2 offset:31744
  ds_read_b64_tr_b16 a[184:185], v2 offset:29184
  ds_read_b64_tr_b16 a[186:187], v2 offset:30208
  ds_read_b64_tr_b16 a[188:189], v2 offset:31232
  ds_read_b64_tr_b16 a[190:191], v2 offset:32256
  s_waitcnt lgkmcnt(8)
  s_add_u32 m0, s52, 24576
  s_add_u32 s38, s45, 1232896
  buffer_load_dwordx4 v3, s[20:23], s38 offen lds
  s_add_u32 m0, s52, 25600
  s_add_u32 s38, s45, 1235648
  buffer_load_dwordx4 v3, s[20:23], s38 offen lds
  s_add_u32 m0, s52, 26624
  s_add_u32 s38, s45, 1276928
  buffer_load_dwordx4 v3, s[20:23], s38 offen lds
  s_add_u32 m0, s52, 27648
  s_add_u32 s38, s45, 1279680
  buffer_load_dwordx4 v3, s[20:23], s38 offen lds
  s_waitcnt vmcnt(28)
  ds_read_b64_tr_b16 a[64:65], v2 offset:32768
  ds_read_b64_tr_b16 a[66:67], v2 offset:33792
  ds_read_b64_tr_b16 a[68:69], v2 offset:34816
  ds_read_b64_tr_b16 a[70:71], v2 offset:35840
  ds_read_b64_tr_b16 a[72:73], v2 offset:33280
  ds_read_b64_tr_b16 a[74:75], v2 offset:34304
  ds_read_b64_tr_b16 a[76:77], v2 offset:35328
  ds_read_b64_tr_b16 a[78:79], v2 offset:36352
  s_waitcnt vmcnt(24)
  ds_read_b64_tr_b16 a[192:193], v2 offset:0
  ds_read_b64_tr_b16 a[194:195], v2 offset:1024
  ds_read_b64_tr_b16 a[196:197], v2 offset:2048
  ds_read_b64_tr_b16 a[198:199], v2 offset:3072
  ds_read_b64_tr_b16 a[200:201], v2 offset:512
  ds_read_b64_tr_b16 a[202:203], v2 offset:1536
  ds_read_b64_tr_b16 a[204:205], v2 offset:2560
  ds_read_b64_tr_b16 a[206:207], v2 offset:3584
  s_waitcnt vmcnt(20)
  ds_read_b64_tr_b16 a[80:81], v2 offset:4096
  ds_read_b64_tr_b16 a[82:83], v2 offset:5120
  ds_read_b64_tr_b16 a[84:85], v2 offset:6144
  ds_read_b64_tr_b16 a[86:87], v2 offset:7168
  ds_read_b64_tr_b16 a[88:89], v2 offset:4608
  ds_read_b64_tr_b16 a[90:91], v2 offset:5632
  ds_read_b64_tr_b16 a[92:93], v2 offset:6656
  ds_read_b64_tr_b16 a[94:95], v2 offset:7680
  s_waitcnt vmcnt(16)
  ds_read_b64_tr_b16 a[208:209], v2 offset:8192
  ds_read_b64_tr_b16 a[210:211], v2 offset:9216
  ds_read_b64_tr_b16 a[212:213], v2 offset:10240
  ds_read_b64_tr_b16 a[214:215], v2 offset:11264
  ds_read_b64_tr_b16 a[216:217], v2 offset:8704
  ds_read_b64_tr_b16 a[218:219], v2 offset:9728
  ds_read_b64_tr_b16 a[220:221], v2 offset:10752
  ds_read_b64_tr_b16 a[222:223], v2 offset:11776
  s_waitcnt vmcnt(12)
  ds_read_b64_tr_b16 a[96:97], v2 offset:12288
  ds_read_b64_tr_b16 a[98:99], v2 offset:13312
  ds_read_b64_tr_b16 a[100:101], v2 offset:14336
  ds_read_b64_tr_b16 a[102:103], v2 offset:15360
  ds_read_b64_tr_b16 a[104:105], v2 offset:12800
  ds_read_b64_tr_b16 a[106:107], v2 offset:13824
  ds_read_b64_tr_b16 a[108:109], v2 offset:14848
  ds_read_b64_tr_b16 a[110:111], v2 offset:15872
  s_waitcnt vmcnt(8)
  ds_read_b64_tr_b16 a[224:225], v2 offset:16384
  ds_read_b64_tr_b16 a[226:227], v2 offset:17408
  ds_read_b64_tr_b16 a[228:229], v2 offset:18432
  ds_read_b64_tr_b16 a[230:231], v2 offset:19456
  ds_read_b64_tr_b16 a[232:233], v2 offset:16896
  ds_read_b64_tr_b16 a[234:235], v2 offset:17920
  ds_read_b64_tr_b16 a[236:237], v2 offset:18944
  ds_read_b64_tr_b16 a[238:239], v2 offset:19968
  s_waitcnt vmcnt(4)
  ds_read_b64_tr_b16 a[112:113], v2 offset:20480
  ds_read_b64_tr_b16 a[114:115], v2 offset:21504
  ds_read_b64_tr_b16 a[116:117], v2 offset:22528
  ds_read_b64_tr_b16 a[118:119], v2 offset:23552
  ds_read_b64_tr_b16 a[120:121], v2 offset:20992
  ds_read_b64_tr_b16 a[122:123], v2 offset:22016
  ds_read_b64_tr_b16 a[124:125], v2 offset:23040
  ds_read_b64_tr_b16 a[126:127], v2 offset:24064
  s_waitcnt vmcnt(0)
  ds_read_b64_tr_b16 a[240:241], v2 offset:24576
  ds_read_b64_tr_b16 a[242:243], v2 offset:25600
  ds_read_b64_tr_b16 a[244:245], v2 offset:26624
  ds_read_b64_tr_b16 a[246:247], v2 offset:27648
  ds_read_b64_tr_b16 a[248:249], v2 offset:25088
  ds_read_b64_tr_b16 a[250:251], v2 offset:26112
  ds_read_b64_tr_b16 a[252:253], v2 offset:27136
  ds_read_b64_tr_b16 a[254:255], v2 offset:28160
  s_waitcnt lgkmcnt(0)
  s_barrier
  s_lshl_b32 s43, s32, 13
  s_add_u32 s42, s43, 2097152
  v_mov_b32 v4, v0
  s_mov_b32 s44, -1
  s_min_u32 s36, s40, 63
  s_lshl_b32 s36, s36, 15
  s_add_u32 s36, s36, s42
  s_add_u32 s37, s36, 4096
  s_mov_b32 m0, s43
  s_nop 0
  buffer_load_dwordx4 v0, s[8:11], s36 offen offset:0 sc1 lds
  buffer_load_dwordx4 v0, s[8:11], s36 offen offset:1024 sc1 lds
  buffer_load_dwordx4 v0, s[8:11], s36 offen offset:2048 sc1 lds
  buffer_load_dwordx4 v0, s[8:11], s36 offen offset:3072 sc1 lds
  s_add_u32 m0, s43, 4096
  s_nop 0
  buffer_load_dwordx4 v0, s[8:11], s37 offen offset:0 sc1 lds
  buffer_load_dwordx4 v0, s[8:11], s37 offen offset:1024 sc1 lds
  buffer_load_dwordx4 v0, s[8:11], s37 offen offset:2048 sc1 lds
  buffer_load_dwordx4 v0, s[8:11], s37 offen offset:3072 sc1 lds
  s_xor_b32 s43, s43, 0x8000
  s_waitcnt vmcnt(0)
gu_top:
  s_barrier
  s_add_u32 s41, s40, 11
  s_min_u32 s36, s41, 63
  s_lshl_b32 s36, s36, 15
  s_add_u32 s36, s36, s42
  s_add_u32 s37, s36, 4096
  s_mov_b32 m0, s43
  s_nop 0
  buffer_load_dwordx4 v0, s[8:11], s36 offen offset:0 sc1 lds
  buffer_load_dwordx4 v0, s[8:11], s36 offen offset:1024 sc1 lds
  buffer_load_dwordx4 v0, s[8:11], s36 offen offset:2048 sc1 lds
  buffer_load_dwordx4 v0, s[8:11], s36 offen offset:3072 sc1 lds
  s_add_u32 m0, s43, 4096
  s_nop 0
  buffer_load_dwordx4 v0, s[8:11], s37 offen offset:0 sc1 lds
  buffer_load_dwordx4 v0, s[8:11], s37 offen offset:1024 sc1 lds
  buffer_load_dwordx4 v0, s[8:11], s37 offen offset:2048 sc1 lds
  buffer_load_dwordx4 v0, s[8:11], s37 offen offset:3072 sc1 lds
  s_xor_b32 s43, s43, 0x8000
  s_cmp_eq_u32 s50, 0
  s_cbranch_scc1 gu_skip
  ds_read_b128 v[8:11], v4 offset:0
  ds_read_b128 v[12:15], v4 offset:16384
  s_waitcnt lgkmcnt(0)
  ds_read_b128 v[16:19], v4 offset:1024
  ds_read_b128 v[20:23], v4 offset:17408
  v_mfma_f32_16x16x32_bf16 v[24:27], a[0:3], v[8:11], 0
  v_mfma_f32_16x16x32_bf16 v[28:31], a[0:3], v[12:15], 0
  v_mfma_f32_16x16x32_bf16 v[32:35], a[8:11], v[8:11], 0
  v_mfma_f32_16x16x32_bf16 v[36:39], a[8:11], v[12:15], 0
  v_mfma_f32_16x16x32_bf16 v[40:43], a[128:131], v[8:11], 0
  v_mfma_f32_16x16x32_bf16 v[44:47], a[128:131], v[12:15], 0
  v_mfma_f32_16x16x32_bf16 v[48:51], a[136:139], v[8:11], 0
  v_mfma_f32_16x16x32_bf16 v[52:55], a[136:139], v[12:15], 0
  s_waitcnt lgkmcnt(0)
  ds_read_b128 v[8:11], v4 offset:2048
  ds_read_b128 v[12:15], v4 offset:18432
  v_mfma_f32_16x16x32_bf16 v[24:27], a[4:7], v[16:19], v[24:27]
  v_mfma_f32_16x16x32_bf16 v[28:31], a[4:7], v[20:23], v[28:31]
  v_mfma_f32_16x16x32_bf16 v[32:35], a[12:15], v[16:19], v[32:35]
  v_mfma_f32_16x16x32_bf16 v[36:39], a[12:15], v[20:23], v[36:39]
  v_mfma_f32_16x16x32_bf16 v[40:43], a[132:135], v[16:19], v[40:43]
  v_mfma_f32_16x16x32_bf16 v[44:47], a[132:135], v[20:23], v[44:47]
  v_mfma_f32_16x16x32_bf16 v[48:51], a[140:143], v[16:19], v[48:51]
  v_mfma_f32_16x16x32_bf16 v[52:55], a[140:143], v[20:23], v[52:55]
  s_waitcnt lgkmcnt(0)
  ds_read_b128 v[16:19], v4 offset:3072
  ds_read_b128 v[20:23], v4 offset:19456
  v_mfma_f32_16x16x32_bf16 v[24:27], a[16:19], v[8:11], v[24:27]
  v_mfma_f32_16x16x32_bf16 v[28:31], a[16:19], v[12:15], v[28:31]
  v_mfma_f32_16x16x32_bf16 v[32:35], a[24:27], v[8:11], v[32:35]
  v_mfma_f32_16x16x32_bf16 v[36:39], a[24:27], v[12:15], v[36:39]
  v_mfma_f32_16x16x32_bf16 v[40:43], a[144:147], v[8:11], v[40:43]
  v_mfma_f32_16x16x32_bf16 v[44:47], a[144:147], v[12:15], v[44:47]
  v_mfma_f32_16x16x32_bf16 v[48:51], a[152:155], v[8:11], v[48:51]
  v_mfma_f32_16x16x32_bf16 v[52:55], a[152:155], v[12:15], v[52:55]
  s_waitcnt lgkmcnt(0)
  ds_read_b128 v[8:11], v4 offset:4096
  ds_read_b128 v[12:15], v4 offset:20480
  v_mfma_f32_16x16x32_bf16 v[24:27], a[20:23], v[16:19], v[24:27]
  v_mfma_f32_16x16x32_bf16 v[28:31], a[20:23], v[20:23], v[28:31]
  v_mfma_f32_16x16x32_bf16 v[32:35], a[28:31], v[16:19], v[32:35]
  v_mfma_f32_16x16x32_bf16 v[36:39], a[28:31], v[20:23], v[36:39]
  v_mfma_f32_16x16x32_bf16 v[40:43], a[148:151], v[16:19], v[40:43]
  v_mfma_f32_16x16x32_bf16 v[44:47], a[148:151], v[20:23], v[44:47]
  v_mfma_f32_16x16x32_bf16 v[48:51], a[156:159], v[16:19], v[48:51]
  v_mfma_f32_16x16x32_bf16 v[52:55], a[156:159], v[20:23], v[52:55]
  s_waitcnt lgkmcnt(0)
  ds_read_b128 v[16:19], v4 offset:5120
  ds_read_b128 v[20:23], v4 offset:21504
  v_mfma_f32_16x16x32_bf16 v[24:27], a[32:35], v[8:11], v[24:27]
  v_mfma_f32_16x16x32_bf16 v[28:31], a[32:35], v[12:15], v[28:31]
  v_mfma_f32_16x16x32_bf16 v[32:35], a[40:43], v[8:11], v[32:35]
  v_mfma_f32_16x16x32_bf16 v[36:39], a[40:43], v[12:15], v[36:39]
  v_mfma_f32_16x16x32_bf16 v[40:43], a[160:163], v[8:11], v[40:43]
  v_mfma_f32_16x16x32_bf16 v[44:47], a[160:163], v[12:15], v[44:47]
  v_mfma_f32_16x16x32_bf16 v[48:51], a[168:171], v[8:11], v[48:51]
  v_mfma_f32_16x16x32_bf16 v[52:55], a[168:171], v[12:15], v[52:55]
  s_waitcnt lgkmcnt(0)
  ds_read_b128 v[8:11], v4 offset:6144
  ds_read_b128 v[12:15], v4 offset:22528
  v_mfma_f32_16x16x32_bf16 v[24:27], a[36:39], v[16:19], v[24:27]
  v_mfma_f32_16x16x32_bf16 v[28:31], a[36:39], v[20:23], v[28:31]
  v_mfma_f32_16x16x32_bf16 v[32:35], a[44:47], v[16:19], v[32:35]
  v_mfma_f32_16x16x32_bf16 v[36:39], a[44:47], v[20:23], v[36:39]
  v_mfma_f32_16x16x32_bf16 v[40:43], a[164:167], v[16:19], v[40:43]
  v_mfma_f32_16x16x32_bf16 v[44:47], a[164:167], v[20:23], v[44:47]
  v_mfma_f32_16x16x32_bf16 v[48:51], a[172:175], v[16:19], v[48:51]
  v_mfma_f32_16x16x32_bf16 v[52:55], a[172:175], v[20:23], v[52:55]
  s_waitcnt lgkmcnt(0)
  ds_read_b128 v[16:19], v4 offset:7168
  ds_read_b128 v[20:23], v4 offset:23552
  v_mfma_f32_16x16x32_bf16 v[24:27], a[48:51], v[8:11], v[24:27]
  v_mfma_f32_16x16x32_bf16 v[28:31], a[48:51], v[12:15], v[28:31]
  v_mfma_f32_16x16x32_bf16 v[32:35], a[56:59], v[8:11], v[32:35]
  v_mfma_f32_16x16x32_bf16 v[36:39], a[56:59], v[12:15], v[36:39]
  v_mfma_f32_16x16x32_bf16 v[40:43], a[176:179], v[8:11], v[40:43]
  v_mfma_f32_16x16x32_bf16 v[44:47], a[176:179], v[12:15], v[44:47]
  v_mfma_f32_16x16x32_bf16 v[48:51], a[184:187], v[8:11], v[48:51]
  v_mfma_f32_16x16x32_bf16 v[52:55], a[184:187], v[12:15], v[52:55]
  s_waitcnt lgkmcnt(0)
  ds_read_b128 v[8:11], v4 offset:8192
  ds_read_b128 v[12:15], v4 offset:24576
  v_mfma_f32_16x16x32_bf16 v[24:27], a[52:55], v[16:19], v[24:27]
  v_mfma_f32_16x16x32_bf16 v[28:31], a[52:55], v[20:23], v[28:31]
  v_mfma_f32_16x16x32_bf16 v[32:35], a[60:63], v[16:19], v[32:35]
  v_mfma_f32_16x16x32_bf16 v[36:39], a[60:63], v[20:23], v[36:39]
  v_mfma_f32_16x16x32_bf16 v[40:43], a[180:183], v[16:19], v[40:43]
  v_mfma_f32_16x16x32_bf16 v[44:47], a[180:183], v[20:23], v[44:47]
  v_mfma_f32_16x16x32_bf16 v[48:51], a[188:191], v[16:19], v[48:51]
  v_mfma_f32_16x16x32_bf16 v[52:55], a[188:191], v[20:23], v[52:55]
  s_waitcnt lgkmcnt(0)
  ds_read_b128 v[16:19], v4 offset:9216
  ds_read_b128 v[20:23], v4 offset:25600
  v_mfma_f32_16x16x32_bf16 v[24:27], a[64:67], v[8:11], v[24:27]
  v_mfma_f32_16x16x32_bf16 v[28:31], a[64:67], v[12:15], v[28:31]
  v_mfma_f32_16x16x32_bf16 v[32:35], a[72:75], v[8:11], v[32:35]
  v_mfma_f32_16x16x32_bf16 v[36:39], a[72:75], v[12:15], v[36:39]
  v_mfma_f32_16x16x32_bf16 v[40:43], a[192:195], v[8:11], v[40:43]
  v_mfma_f32_16x16x32_bf16 v[44:47], a[192:195], v[12:15], v[44:47]
  v_mfma_f32_16x16x32_bf16 v[48:51], a[200:203], v[8:11], v[48:51]
  v_mfma_f32_16x16x32_bf16 v[52:55], a[200:203], v[12:15], v[52:55]
  s_waitcnt lgkmcnt(0)
  ds_read_b128 v[8:11], v4 offset:10240
  ds_read_b128 v[12:15], v4 offset:26624
  v_mfma_f32_16x16x32_bf16 v[24:27], a[68:71], v[16:19], v[24:27]
  v_mfma_f32_16x16x32_bf16 v[28:31], a[68:71], v[20:23], v[28:31]
  v_mfma_f32_16x16x32_bf16 v[32:35], a[76:79], v[16:19], v[32:35]
  v_mfma_f32_16x16x32_bf16 v[36:39], a[76:79], v[20:23], v[36:39]
  v_mfma_f32_16x16x32_bf16 v[40:43], a[196:199], v[16:19], v[40:43]
  v_mfma_f32_16x16x32_bf16 v[44:47], a[196:199], v[20:23], v[44:47]
  v_mfma_f32_16x16x32_bf16 v[48:51], a[204:207], v[16:19], v[48:51]
  v_mfma_f32_16x16x32_bf16 v[52:55], a[204:207], v[20:23], v[52:55]
  s_waitcnt lgkmcnt(0)
  ds_read_b128 v[16:19], v4 offset:11264
  ds_read_b128 v[20:23], v4 offset:27648
  v_mfma_f32_16x16x32_bf16 v[24:27], a[80:83], v[8:11], v[24:27]
  v_mfma_f32_16x16x32_bf16 v[28:31], a[80:83], v[12:15], v[28:31]
  v_mfma_f32_16x16x32_bf16 v[32:35], a[88:91], v[8:11], v[32:35]
  v_mfma_f32_16x16x32_bf16 v[36:39], a[88:91], v[12:15], v[36:39]
  v_mfma_f32_16x16x32_bf16 v[40:43], a[208:211], v[8:11], v[40:43]
  v_mfma_f32_16x16x32_bf16 v[44:47], a[208:211], v[12:15], v[44:47]
  v_mfma_f32_16x16x32_bf16 v[48:51], a[216:219], v[8:11], v[48:51]
  v_mfma_f32_16x16x32_bf16 v[52:55], a[216:219], v[12:15], v[52:55]
  s_waitcnt lgkmcnt(0)
  ds_read_b128 v[8:11], v4 offset:12288
  ds_read_b128 v[12:15], v4 offset:28672
  v_mfma_f32_16x16x32_bf16 v[24:27], a[84:87], v[16:19], v[24:27]
  v_mfma_f32_16x16x32_bf16 v[28:31], a[84:87], v[20:23], v[28:31]
  v_mfma_f32_16x16x32_bf16 v[32:35], a[92:95], v[16:19], v[32:35]
  v_mfma_f32_16x16x32_bf16 v[36:39], a[92:95], v[20:23], v[36:39]
  v_mfma_f32_16x16x32_bf16 v[40:43], a[212:215], v[16:19], v[40:43]
  v_mfma_f32_16x16x32_bf16 v[44:47], a[212:215], v[20:23], v[44:47]
  v_mfma_f32_16x16x32_bf16 v[48:51], a[220:223], v[16:19], v[48:51]
  v_mfma_f32_16x16x32_bf16 v[52:55], a[220:223], v[20:23], v[52:55]
  s_waitcnt lgkmcnt(0)
  ds_read_b128 v[16:19], v4 offset:13312
  ds_read_b128 v[20:23], v4 offset:29696
  v_mfma_f32_16x16x32_bf16 v[24:27], a[96:99], v[8:11], v[24:27]
  v_mfma_f32_16x16x32_bf16 v[28:31], a[96:99], v[12:15], v[28:31]
  v_mfma_f32_16x16x32_bf16 v[32:35], a[104:107], v[8:11], v[32:35]
  v_mfma_f32_16x16x32_bf16 v[36:39], a[104:107], v[12:15], v[36:39]
  v_mfma_f32_16x16x32_bf16 v[40:43], a[224:227], v[8:11], v[40:43]
  v_mfma_f32_16x16x32_bf16 v[44:47], a[224:227], v[12:15], v[44:47]
  v_mfma_f32_16x16x32_bf16 v[48:51], a[232:235], v[8:11], v[48:51]
  v_mfma_f32_16x16x32_bf16 v[52:55], a[232:235], v[12:15], v[52:55]
  s_waitcnt lgkmcnt(0)
  ds_read_b128 v[8:11], v4 offset:14336
  ds_read_b128 v[12:15], v4 offset:30720
  v_mfma_f32_16x16x32_bf16 v[24:27], a[100:103], v[16:19], v[24:27]
  v_mfma_f32_16x16x32_bf16 v[28:31], a[100:103], v[20:23], v[28:31]
  v_mfma_f32_16x16x32_bf16 v[32:35], a[108:111], v[16:19], v[32:35]
  v_mfma_f32_16x16x32_bf16 v[36:39], a[108:111], v[20:23], v[36:39]
  v_mfma_f32_16x16x32_bf16 v[40:43], a[228:231], v[16:19], v[40:43]
  v_mfma_f32_16x16x32_bf16 v[44:47], a[228:231], v[20:23], v[44:47]
  v_mfma_f32_16x16x32_bf16 v[48:51], a[236:239], v[16:19], v[48:51]
  v_mfma_f32_16x16x32_bf16 v[52:55], a[236:239], v[20:23], v[52:55]
  s_waitcnt vmcnt(0)
  s_cmp_lt_i32 s44, 0
  s_cbranch_scc1 gu_noflag
  s_lshl_b32 s36, s44, 7
  s_add_u32 s36, s36, 16384
  s_mov_b64 exec, 1
  v_mov_b32 v6, 1
  v_mov_b32 v7, 0
  buffer_atomic_add v6, v7, s[8:11], s36 offen sc1
  s_mov_b64 exec, -1
gu_noflag:
  s_waitcnt lgkmcnt(0)
  ds_read_b128 v[16:19], v4 offset:15360
  ds_read_b128 v[20:23], v4 offset:31744
  v_mfma_f32_16x16x32_bf16 v[24:27], a[112:115], v[8:11], v[24:27]
  v_mfma_f32_16x16x32_bf16 v[28:31], a[112:115], v[12:15], v[28:31]
  v_mfma_f32_16x16x32_bf16 v[32:35], a[120:123], v[8:11], v[32:35]
  v_mfma_f32_16x16x32_bf16 v[36:39], a[120:123], v[12:15], v[36:39]
  v_mfma_f32_16x16x32_bf16 v[40:43], a[240:243], v[8:11], v[40:43]
  v_mfma_f32_16x16x32_bf16 v[44:47], a[240:243], v[12:15], v[44:47]
  v_mfma_f32_16x16x32_bf16 v[48:51], a[248:251], v[8:11], v[48:51]
  v_mfma_f32_16x16x32_bf16 v[52:55], a[248:251], v[12:15], v[52:55]
  s_waitcnt lgkmcnt(0)
  v_mfma_f32_16x16x32_bf16 v[24:27], a[116:119], v[16:19], v[24:27]
  v_mfma_f32_16x16x32_bf16 v[28:31], a[116:119], v[20:23], v[28:31]
  v_mfma_f32_16x16x32_bf16 v[32:35], a[124:127], v[16:19], v[32:35]
  v_mfma_f32_16x16x32_bf16 v[36:39], a[124:127], v[20:23], v[36:39]
  v_mfma_f32_16x16x32_bf16 v[40:43], a[244:247], v[16:19], v[40:43]
  v_mfma_f32_16x16x32_bf16 v[44:47], a[244:247], v[20:23], v[44:47]
  v_mfma_f32_16x16x32_bf16 v[48:51], a[252:255], v[16:19], v[48:51]
  v_mfma_f32_16x16x32_bf16 v[52:55], a[252:255], v[20:23], v[52:55]
  s_mul_i32 s36, s40, 90112
  s_lshl_b32 s37, s49, 10
  s_add_u32 s36, s36, s37
  s_add_u32 s36, s36, 83886080
  s_add_u32 s37, s36, 45056
  s_mov_b32 s38, 3184710632
  v_mov_b32 v56, 3222493025
  v_mul_f32 v60, v24, v24
  v_mul_f32 v61, v25, v25
  v_mul_f32 v62, v26, v26
  v_mul_f32 v63, v27, v27
  v_fma_f32 v60, v60, s38, v56
  v_fma_f32 v61, v61, s38, v56
  v_fma_f32 v62, v62, s38, v56
  v_fma_f32 v63, v63, s38, v56
  v_mul_f32 v60, v60, v24
  v_mul_f32 v61, v61, v25
  v_mul_f32 v62, v62, v26
  v_mul_f32 v63, v63, v27
  v_exp_f32 v60, v60
  v_exp_f32 v61, v61
  v_exp_f32 v62, v62
  v_exp_f32 v63, v63
  v_mul_f32 v24, v24, v40
  v_mul_f32 v25, v25, v41
  v_mul_f32 v26, v26, v42
  v_mul_f32 v27, v27, v43
  v_add_f32 v60, 1.0, v60
  v_add_f32 v61, 1.0, v61
  v_add_f32 v62, 1.0, v62
  v_add_f32 v63, 1.0, v63
  v_rcp_f32 v60, v60
  v_rcp_f32 v61, v61
  v_rcp_f32 v62, v62
  v_rcp_f32 v63, v63
  v_mul_f32 v24, v24, v60
  v_mul_f32 v25, v25, v61
  v_mul_f32 v26, v26, v62
  v_mul_f32 v27, v27, v63
  v_cvt_pk_bf16_f32 v72, v24, v25
  v_cvt_pk_bf16_f32 v73, v26, v27
  v_mul_f32 v60, v32, v32
  v_mul_f32 v61, v33, v33
  v_mul_f32 v62, v34, v34
  v_mul_f32 v63, v35, v35
  v_fma_f32 v60, v60, s38, v56
  v_fma_f32 v61, v61, s38, v56
  v_fma_f32 v62, v62, s38, v56
  v_fma_f32 v63, v63, s38, v56
  v_mul_f32 v60, v60, v32
  v_mul_f32 v61, v61, v33
  v_mul_f32 v62, v62, v34
  v_mul_f32 v63, v63, v35
  v_exp_f32 v60, v60
  v_exp_f32 v61, v61
  v_exp_f32 v62, v62
  v_exp_f32 v63, v63
  v_mul_f32 v32, v32, v48
  v_mul_f32 v33, v33, v49
  v_mul_f32 v34, v34, v50
  v_mul_f32 v35, v35, v51
  v_add_f32 v60, 1.0, v60
  v_add_f32 v61, 1.0, v61
  v_add_f32 v62, 1.0, v62
  v_add_f32 v63, 1.0, v63
  v_rcp_f32 v60, v60
  v_rcp_f32 v61, v61
  v_rcp_f32 v62, v62
  v_rcp_f32 v63, v63
  v_mul_f32 v32, v32, v60
  v_mul_f32 v33, v33, v61
  v_mul_f32 v34, v34, v62
  v_mul_f32 v35, v35, v63
  v_cvt_pk_bf16_f32 v74, v32, v33
  v_cvt_pk_bf16_f32 v75, v34, v35
  buffer_store_dwordx4 v[72:75], v0, s[8:11], s36 offen sc1
  v_mul_f32 v60, v28, v28
  v_mul_f32 v61, v29, v29
  v_mul_f32 v62, v30, v30
  v_mul_f32 v63, v31, v31
  v_fma_f32 v60, v60, s38, v56
  v_fma_f32 v61, v61, s38, v56
  v_fma_f32 v62, v62, s38, v56
  v_fma_f32 v63, v63, s38, v56
  v_mul_f32 v60, v60, v28
  v_mul_f32 v61, v61, v29
  v_mul_f32 v62, v62, v30
  v_mul_f32 v63, v63, v31
  v_exp_f32 v60, v60
  v_exp_f32 v61, v61
  v_exp_f32 v62, v62
  v_exp_f32 v63, v63
  v_mul_f32 v28, v28, v44
  v_mul_f32 v29, v29, v45
  v_mul_f32 v30, v30, v46
  v_mul_f32 v31, v31, v47
  v_add_f32 v60, 1.0, v60
  v_add_f32 v61, 1.0, v61
  v_add_f32 v62, 1.0, v62
  v_add_f32 v63, 1.0, v63
  v_rcp_f32 v60, v60
  v_rcp_f32 v61, v61
  v_rcp_f32 v62, v62
  v_rcp_f32 v63, v63
  v_mul_f32 v28, v28, v60
  v_mul_f32 v29, v29, v61
  v_mul_f32 v30, v30, v62
  v_mul_f32 v31, v31, v63
  v_cvt_pk_bf16_f32 v76, v28, v29
  v_cvt_pk_bf16_f32 v77, v30, v31
  v_mul_f32 v60, v36, v36
  v_mul_f32 v61, v37, v37
  v_mul_f32 v62, v38, v38
  v_mul_f32 v63, v39, v39
  v_fma_f32 v60, v60, s38, v56
  v_fma_f32 v61, v61, s38, v56
  v_fma_f32 v62, v62, s38, v56
  v_fma_f32 v63, v63, s38, v56
  v_mul_f32 v60, v60, v36
  v_mul_f32 v61, v61, v37
  v_mul_f32 v62, v62, v38
  v_mul_f32 v63, v63, v39
  v_exp_f32 v60, v60
  v_exp_f32 v61, v61
  v_exp_f32 v62, v62
  v_exp_f32 v63, v63
  v_mul_f32 v36, v36, v52
  v_mul_f32 v37, v37, v53
  v_mul_f32 v38, v38, v54
  v_mul_f32 v39, v39, v55
  v_add_f32 v60, 1.0, v60
  v_add_f32 v61, 1.0, v61
  v_add_f32 v62, 1.0, v62
  v_add_f32 v63, 1.0, v63
  v_rcp_f32 v60, v60
  v_rcp_f32 v61, v61
  v_rcp_f32 v62, v62
  v_rcp_f32 v63, v63
  v_mul_f32 v36, v36, v60
  v_mul_f32 v37, v37, v61
  v_mul_f32 v38, v38, v62
  v_mul_f32 v39, v39, v63
  v_cvt_pk_bf16_f32 v78, v36, v37
  v_cvt_pk_bf16_f32 v79, v38, v39
  buffer_store_dwordx4 v[76:79], v0, s[8:11], s37 offen sc1
  s_mov_b32 s44, s40
gu_next:
  v_xor_b32 v4, 0x8000, v4
  s_mov_b32 s40, s41
  s_cmp_lt_u32 s40, 64
  s_cbranch_scc1 gu_top
  s_waitcnt vmcnt(0)
  s_cmp_eq_u32 s50, 0
  s_cbranch_scc1 gu_end
  s_lshl_b32 s36, s44, 7
  s_add_u32 s36, s36, 16384
  s_mov_b64 exec, 1
  v_mov_b32 v6, 1
  v_mov_b32 v7, 0
  buffer_atomic_add v6, v7, s[8:11], s36 offen sc1
  s_mov_b64 exec, -1
  s_branch gu_end
gu_skip:
  s_waitcnt vmcnt(0)
  s_branch gu_next
gu_end:
  s_barrier
L_out:
  s_lshr_b32 s40, s90, 4
  s_and_b32 s48, s90, 15
  s_load_dwordx2 s[4:5], s[0:1], 40
  s_load_dwordx4 s[20:23], s[0:1], 80
  s_load_dwordx2 s[6:7], s[0:1], 0
  s_waitcnt lgkmcnt(0)
  s_mov_b32 s16, s4
  s_and_b32 s17, s5, 0xffff
  s_mov_b32 s18, 4194304
  s_mov_b32 s19, 0x20000
  s_mov_b32 s24, s22
  s_and_b32 s25, s23, 0xffff
  s_mov_b32 s26, 2097152
  s_mov_b32 s27, 0x20000
  s_and_b32 s21, s21, 0xffff
  s_mov_b32 s22, 1409024
  s_mov_b32 s23, 0x20000
  s_mov_b32 s28, s6
  s_and_b32 s29, s7, 0xffff
  s_mov_b32 s30, 2097152
  s_mov_b32 s31, 0x20000
  v_bfe_u32 v21, v1, 1, 4
  v_lshlrev_b32 v21, 10, v21
  v_lshrrev_b32 v22, 5, v1
  v_lshl_add_u32 v21, v22, 5, v21
  v_and_b32 v22, 1, v1
  v_lshl_add_u32 v3, v22, 4, v21
  s_lshl_b32 s37, s48, 6
  s_lshl_b32 s45, s32, 20
  s_add_u32 s45, s45, s37
  s_lshl_b32 s46, s32, 15
  s_add_u32 s46, s46, s37
  s_add_u32 m0, s52, 0
  s_add_u32 s38, s46, 0
  buffer_load_dwordx4 v3, s[20:23], s38 offen lds
  s_add_u32 m0, s52, 1024
  s_add_u32 s38, s46, 16384
  buffer_load_dwordx4 v3, s[20:23], s38 offen lds
  s_add_u32 m0, s52, 2048
  s_add_u32 s38, s46, 131072
  buffer_load_dwordx4 v3, s[20:23], s38 offen lds
  s_add_u32 m0, s52, 3072
  s_add_u32 s38, s46, 147456
  buffer_load_dwordx4 v3, s[20:23], s38 offen lds
  s_add_u32 m0, s52, 4096
  s_add_u32 s38, s46, 262144
  buffer_load_dwordx4 v3, s[20:23], s38 offen lds
  s_add_u32 m0, s52, 5120
  s_add_u32 s38, s46, 278528
  buffer_load_dwordx4 v3, s[20:23], s38 offen lds
  s_add_u32 m0, s52, 6144
  s_add_u32 s38, s46, 393216
  buffer_load_dwordx4 v3, s[20:23], s38 offen lds
  s_add_u32 m0, s52, 7168
  s_add_u32 s38, s46, 409600
  buffer_load_dwordx4 v3, s[20:23], s38 offen lds
  s_add_u32 m0, s52, 8192
  s_add_u32 s38, s46, 524288
  buffer_load_dwordx4 v3, s[20:23], s38 offen lds
  s_add_u32 m0, s52, 9216
  s_add_u32 s38, s46, 540672
  buffer_load_dwordx4 v3, s[20:23], s38 offen lds
  s_add_u32 m0, s52, 10240
  s_add_u32 s38, s46, 655360
  buffer_load_dwordx4 v3, s[20:23], s38 offen lds
  s_add_u32 m0, s52, 11264
  s_add_u32 s38, s46, 671744
  buffer_load_dwordx4 v3, s[20:23], s38 offen lds
  s_add_u32 m0, s52, 12288
  s_add_u32 s38, s46, 786432
  buffer_load_dwordx4 v3, s[20:23], s38 offen lds
  s_add_u32 m0, s52, 13312
  s_add_u32 s38, s46, 802816
  buffer_load_dwordx4 v3, s[20:23], s38 offen lds
  s_add_u32 m0, s52, 14336
  s_add_u32 s38, s46, 917504
  buffer_load_dwordx4 v3, s[20:23], s38 offen lds
  s_add_u32 m0, s52, 15360
  s_add_u32 s38, s46, 933888
  buffer_load_dwordx4 v3, s[20:23], s38 offen lds
  s_add_u32 m0, s52, 16384
  s_add_u32 s38, s46, 1048576
  buffer_load_dwordx4 v3, s[20:23], s38 offen lds
  s_add_u32 m0, s52, 17408
  s_add_u32 s38, s46, 1064960
  buffer_load_dwordx4 v3, s[20:23], s38 offen lds
  s_add_u32 m0, s52, 18432
  s_add_u32 s38, s46, 1179648
  buffer_load_dwordx4 v3, s[20:23], s38 offen lds
  s_add_u32 m0, s52, 19456
  s_add_u32 s38, s46, 1196032
  buffer_load_dwordx4 v3, s[20:23], s38 offen lds
  s_add_u32 m0, s52, 20480
  s_add_u32 s38, s46, 1310720
  buffer_load_dwordx4 v3, s[20:23], s38 offen lds
  s_add_u32 m0, s52, 21504
  s_add_u32 s38, s46, 1327104
  buffer_load_dwordx4 v3, s[20:23], s38 offen lds
  s_add_u32 m0, s52, 22528
  s_add_u32 s38, s46, 1441792
  buffer_load_dwordx4 v3, s[20:23], s38 offen lds
  s_add_u32 m0, s52, 23552
  s_add_u32 s38, s46, 1458176
  buffer_load_dwordx4 v3, s[20:23], s38 offen lds
  s_add_u32 m0, s52, 24576
  s_add_u32 s38, s45, 0
  buffer_load_dwordx4 v3, s[16:19], s38 offen lds
  s_add_u32 m0, s52, 25600
  s_add_u32 s38, s45, 16384
  buffer_load_dwordx4 v3, s[16:19], s38 offen lds
  s_add_u32 m0, s52, 26624
  s_add_u32 s38, s45, 32768
  buffer_load_dwordx4 v3, s[16:19], s38 offen lds
  s_add_u32 m0, s52, 27648
  s_add_u32 s38, s45, 49152
  buffer_load_dwordx4 v3, s[16:19], s38 offen lds
  s_add_u32 m0, s52, 28672
  s_add_u32 s38, s45, 65536
  buffer_load_dwordx4 v3, s[16:19], s38 offen lds
  s_add_u32 m0, s52, 29696
  s_add_u32 s38, s45, 81920
  buffer_load_dwordx4 v3, s[16:19], s38 offen lds
  s_add_u32 m0, s52, 30720
  s_add_u32 s38, s45, 98304
  buffer_load_dwordx4 v3, s[16:19], s38 offen lds
  s_add_u32 m0, s52, 31744
  s_add_u32 s38, s45, 114688
  buffer_load_dwordx4 v3, s[16:19], s38 offen lds
  s_waitcnt vmcnt(28)
  ds_read_b64_tr_b16 v[168:169], v2 offset:0
  ds_read_b64_tr_b16 v[170:171], v2 offset:1024
  ds_read_b64_tr_b16 v[176:177], v2 offset:2048
  ds_read_b64_tr_b16 v[178:179], v2 offset:3072
  ds_read_b64_tr_b16 v[172:173], v2 offset:512
  ds_read_b64_tr_b16 v[174:175], v2 offset:1536
  ds_read_b64_tr_b16 v[180:181], v2 offset:2560
  ds_read_b64_tr_b16 v[182:183], v2 offset:3584
  s_waitcnt lgkmcnt(8)
  s_add_u32 m0, s52, 32768
  s_add_u32 s38, s45, 131072
  buffer_load_dwordx4 v3, s[16:19], s38 offen lds
  s_add_u32 m0, s52, 33792
  s_add_u32 s38, s45, 147456
  buffer_load_dwordx4 v3, s[16:19], s38 offen lds
  s_add_u32 m0, s52, 34816
  s_add_u32 s38, s45, 163840
  buffer_load_dwordx4 v3, s[16:19], s38 offen lds
  s_add_u32 m0, s52, 35840
  s_add_u32 s38, s45, 180224
  buffer_load_dwordx4 v3, s[16:19], s38 offen lds
  s_waitcnt vmcnt(28)
  ds_read_b64_tr_b16 v[184:185], v2 offset:4096
  ds_read_b64_tr_b16 v[186:187], v2 offset:5120
  ds_read_b64_tr_b16 v[192:193], v2 offset:6144
  ds_read_b64_tr_b16 v[194:195], v2 offset:7168
  ds_read_b64_tr_b16 v[188:189], v2 offset:4608
  ds_read_b64_tr_b16 v[190:191], v2 offset:5632
  ds_read_b64_tr_b16 v[196:197], v2 offset:6656
  ds_read_b64_tr_b16 v[198:199], v2 offset:7680
  s_waitcnt lgkmcnt(8)
  s_add_u32 m0, s52, 0
  s_add_u32 s38, s45, 196608
  buffer_load_dwordx4 v3, s[16:19], s38 offen lds
  s_add_u32 m0, s52, 1024
  s_add_u32 s38, s45, 212992
  buffer_load_dwordx4 v3, s[16:19], s38 offen lds
  s_add_u32 m0, s52, 2048
  s_add_u32 s38, s45, 229376
  buffer_load_dwordx4 v3, s[16:19], s38 offen lds
  s_add_u32 m0, s52, 3072
  s_add_u32 s38, s45, 245760
  buffer_load_dwordx4 v3, s[16:19], s38 offen lds
  s_waitcnt vmcnt(28)
  ds_read_b64_tr_b16 v[200:201], v2 offset:8192
  ds_read_b64_tr_b16 v[202:203], v2 offset:9216
  ds_read_b64_tr_b16 v[208:209], v2 offset:10240
  ds_read_b64_tr_b16 v[210:211], v2 offset:11264
  ds_read_b64_tr_b16 v[204:205], v2 offset:8704
  ds_read_b64_tr_b16 v[206:207], v2 offset:9728
  ds_read_b64_tr_b16 v[212:213], v2 offset:10752
  ds_read_b64_tr_b16 v[214:215], v2 offset:11776
  s_waitcnt lgkmcnt(8)
  s_add_u32 m0, s52, 4096
  s_add_u32 s38, s45, 262144
  buffer_load_dwordx4 v3, s[16:19], s38 offen lds
  s_add_u32 m0, s52, 5120
  s_add_u32 s38, s45, 278528
  buffer_load_dwordx4 v3, s[16:19], s38 offen lds
  s_add_u32 m0, s52, 6144
  s_add_u32 s38, s45, 294912
  buffer_load_dwordx4 v3, s[16:19], s38 offen lds
  s_add_u32 m0, s52, 7168
  s_add_u32 s38, s45, 311296
  buffer_load_dwordx4 v3, s[16:19], s38 offen lds
  s_waitcnt vmcnt(28)
  ds_read_b64_tr_b16 v[216:217], v2 offset:12288
  ds_read_b64_tr_b16 v[218:219], v2 offset:13312
  ds_read_b64_tr_b16 v[224:225], v2 offset:14336
  ds_read_b64_tr_b16 v[226:227], v2 offset:15360
  ds_read_b64_tr_b16 v[220:221], v2 offset:12800
  ds_read_b64_tr_b16 v[222:223], v2 offset:13824
  ds_read_b64_tr_b16 v[228:229], v2 offset:14848
  ds_read_b64_tr_b16 v[230:231], v2 offset:15872
  s_waitcnt lgkmcnt(8)
  s_add_u32 m0, s52, 8192
  s_add_u32 s38, s45, 327680
  buffer_load_dwordx4 v3, s[16:19], s38 offen lds
  s_add_u32 m0, s52, 9216
  s_add_u32 s38, s45, 344064
  buffer_load_dwordx4 v3, s[16:19], s38 offen lds
  s_add_u32 m0, s52, 10240
  s_add_u32 s38, s45, 360448
  buffer_load_dwordx4 v3, s[16:19], s38 offen lds
  s_add_u32 m0, s52, 11264
  s_add_u32 s38, s45, 376832
  buffer_load_dwordx4 v3, s[16:19], s38 offen lds
  s_waitcnt vmcnt(28)
  ds_read_b64_tr_b16 v[232:233], v2 offset:16384
  ds_read_b64_tr_b16 v[234:235], v2 offset:17408
  ds_read_b64_tr_b16 v[240:241], v2 offset:18432
  ds_read_b64_tr_b16 v[242:243], v2 offset:19456
  ds_read_b64_tr_b16 v[236:237], v2 offset:16896
  ds_read_b64_tr_b16 v[238:239], v2 offset:17920
  ds_read_b64_tr_b16 v[244:245], v2 offset:18944
  ds_read_b64_tr_b16 v[246:247], v2 offset:19968
  s_waitcnt lgkmcnt(8)
  s_add_u32 m0, s52, 12288
  s_add_u32 s38, s45, 393216
  buffer_load_dwordx4 v3, s[16:19], s38 offen lds
  s_add_u32 m0, s52, 13312
  s_add_u32 s38, s45, 409600
  buffer_load_dwordx4 v3, s[16:19], s38 offen lds
  s_add_u32 m0, s52, 14336
  s_add_u32 s38, s45, 425984
  buffer_load_dwordx4 v3, s[16:19], s38 offen lds
  s_add_u32 m0, s52, 15360
  s_add_u32 s38, s45, 442368
  buffer_load_dwordx4 v3, s[16:19], s38 offen lds
  s_waitcnt vmcnt(28)
  ds_read_b64_tr_b16 v[248:249], v2 offset:20480
  ds_read_b64_tr_b16 v[250:251], v2 offset:21504
  ds_read_b64_tr_b16 v[32:33], v2 offset:22528
  ds_read_b64_tr_b16 v[34:35], v2 offset:23552
  ds_read_b64_tr_b16 v[252:253], v2 offset:20992
  ds_read_b64_tr_b16 v[254:255], v2 offset:22016
  ds_read_b64_tr_b16 v[36:37], v2 offset:23040
  ds_read_b64_tr_b16 v[38:39], v2 offset:24064
  s_waitcnt lgkmcnt(8)
  s_add_u32 m0, s52, 16384
  s_add_u32 s38, s45, 458752
  buffer_load_dwordx4 v3, s[16:19], s38 offen lds
  s_add_u32 m0, s52, 17408
  s_add_u32 s38, s45, 475136
  buffer_load_dwordx4 v3, s[16:19], s38 offen lds
  s_add_u32 m0, s52, 18432
  s_add_u32 s38, s45, 491520
  buffer_load_dwordx4 v3, s[16:19], s38 offen lds
  s_add_u32 m0, s52, 19456
  s_add_u32 s38, s45, 507904
  buffer_load_dwordx4 v3, s[16:19], s38 offen lds
  s_waitcnt vmcnt(28)
  ds_read_b64_tr_b16 a[0:1], v2 offset:24576
  ds_read_b64_tr_b16 a[2:3], v2 offset:25600
  ds_read_b64_tr_b16 a[8:9], v2 offset:26624
  ds_read_b64_tr_b16 a[10:11], v2 offset:27648
  ds_read_b64_tr_b16 a[4:5], v2 offset:25088
  ds_read_b64_tr_b16 a[6:7], v2 offset:26112
  ds_read_b64_tr_b16 a[12:13], v2 offset:27136
  ds_read_b64_tr_b16 a[14:15], v2 offset:28160
  s_waitcnt lgkmcnt(8)
  s_add_u32 m0, s52, 20480
  s_add_u32 s38, s45, 524288
  buffer_load_dwordx4 v3, s[16:19], s38 offen lds
  s_add_u32 m0, s52, 21504
  s_add_u32 s38, s45, 540672
  buffer_load_dwordx4 v3, s[16:19], s38 offen lds
  s_add_u32 m0, s52, 22528
  s_add_u32 s38, s45, 557056
  buffer_load_dwordx4 v3, s[16:19], s38 offen lds
  s_add_u32 m0, s52, 23552
  s_add_u32 s38, s45, 573440
  buffer_load_dwordx4 v3, s[16:19], s38 offen lds
  s_waitcnt vmcnt(28)
  ds_read_b64_tr_b16 a[16:17], v2 offset:28672
  ds_read_b64_tr_b16 a[18:19], v2 offset:29696
  ds_read_b64_tr_b16 a[24:25], v2 offset:30720
  ds_read_b64_tr_b16 a[26:27], v2 offset:31744
  ds_read_b64_tr_b16 a[20:21], v2 offset:29184
  ds_read_b64_tr_b16 a[22:23], v2 offset:30208
  ds_read_b64_tr_b16 a[28:29], v2 offset:31232
  ds_read_b64_tr_b16 a[30:31], v2 offset:32256
  s_waitcnt lgkmcnt(8)
  s_add_u32 m0, s52, 24576
  s_add_u32 s38, s45, 589824
  buffer_load_dwordx4 v3, s[16:19], s38 offen lds
  s_add_u32 m0, s52, 25600
  s_add_u32 s38, s45, 606208
  buffer_load_dwordx4 v3, s[16:19], s38 offen lds
  s_add_u32 m0, s52, 26624
  s_add_u32 s38, s45, 622592
  buffer_load_dwordx4 v3, s[16:19], s38 offen lds
  s_add_u32 m0, s52, 27648
  s_add_u32 s38, s45, 638976
  buffer_load_dwordx4 v3, s[16:19], s38 offen lds
  s_waitcnt vmcnt(28)
  ds_read_b64_tr_b16 a[32:33], v2 offset:32768
  ds_read_b64_tr_b16 a[34:35], v2 offset:33792
  ds_read_b64_tr_b16 a[40:41], v2 offset:34816
  ds_read_b64_tr_b16 a[42:43], v2 offset:35840
  ds_read_b64_tr_b16 a[36:37], v2 offset:33280
  ds_read_b64_tr_b16 a[38:39], v2 offset:34304
  ds_read_b64_tr_b16 a[44:45], v2 offset:35328
  ds_read_b64_tr_b16 a[46:47], v2 offset:36352
  s_waitcnt lgkmcnt(8)
  s_add_u32 m0, s52, 28672
  s_add_u32 s38, s45, 655360
  buffer_load_dwordx4 v3, s[16:19], s38 offen lds
  s_add_u32 m0, s52, 29696
  s_add_u32 s38, s45, 671744
  buffer_load_dwordx4 v3, s[16:19], s38 offen lds
  s_add_u32 m0, s52, 30720
  s_add_u32 s38, s45, 688128
  buffer_load_dwordx4 v3, s[16:19], s38 offen lds
  s_add_u32 m0, s52, 31744
  s_add_u32 s38, s45, 704512
  buffer_load_dwordx4 v3, s[16:19], s38 offen lds
  s_waitcnt vmcnt(28)
  ds_read_b64_tr_b16 a[48:49], v2 offset:0
  ds_read_b64_tr_b16 a[50:51], v2 offset:1024
  ds_read_b64_tr_b16 a[56:57], v2 offset:2048
  ds_read_b64_tr_b16 a[58:59], v2 offset:3072
  ds_read_b64_tr_b16 a[52:53], v2 offset:512
  ds_read_b64_tr_b16 a[54:55], v2 offset:1536
  ds_read_b64_tr_b16 a[60:61], v2 offset:2560
  ds_read_b64_tr_b16 a[62:63], v2 offset:3584
  s_waitcnt lgkmcnt(8)
  s_add_u32 m0, s52, 32768
  s_add_u32 s38, s45, 720896
  buffer_load_dwordx4 v3, s[16:19], s38 offen lds
  s_add_u32 m0, s52, 33792
  s_add_u32 s38, s45, 737280
  buffer_load_dwordx4 v3, s[16:19], s38 offen lds
  s_add_u32 m0, s52, 34816
  s_add_u32 s38, s45, 753664
  buffer_load_dwordx4 v3, s[16:19], s38 offen lds
  s_add_u32 m0, s52, 35840
  s_add_u32 s38, s45, 770048
  buffer_load_dwordx4 v3, s[16:19], s38 offen lds
  s_waitcnt vmcnt(28)
  ds_read_b64_tr_b16 a[64:65], v2 offset:4096
  ds_read_b64_tr_b16 a[66:67], v2 offset:5120
  ds_read_b64_tr_b16 a[72:73], v2 offset:6144
  ds_read_b64_tr_b16 a[74:75], v2 offset:7168
  ds_read_b64_tr_b16 a[68:69], v2 offset:4608
  ds_read_b64_tr_b16 a[70:71], v2 offset:5632
  ds_read_b64_tr_b16 a[76:77], v2 offset:6656
  ds_read_b64_tr_b16 a[78:79], v2 offset:7680
  s_waitcnt lgkmcnt(8)
  s_add_u32 m0, s52, 0
  s_add_u32 s38, s45, 786432
  buffer_load_dwordx4 v3, s[16:19], s38 offen lds
  s_add_u32 m0, s52, 1024
  s_add_u32 s38, s45, 802816
  buffer_load_dwordx4 v3, s[16:19], s38 offen lds
  s_add_u32 m0, s52, 2048
  s_add_u32 s38, s45, 819200
  buffer_load_dwordx4 v3, s[16:19], s38 offen lds
  s_add_u32 m0, s52, 3072
  s_add_u32 s38, s45, 835584
  buffer_load_dwordx4 v3, s[16:19], s38 offen lds
  s_waitcnt vmcnt(28)
  ds_read_b64_tr_b16 a[80:81], v2 offset:8192
  ds_read_b64_tr_b16 a[82:83], v2 offset:9216
  ds_read_b64_tr_b16 a[88:89], v2 offset:10240
  ds_read_b64_tr_b16 a[90:91], v2 offset:11264
  ds_read_b64_tr_b16 a[84:85], v2 offset:8704
  ds_read_b64_tr_b16 a[86:87], v2 offset:9728
  ds_read_b64_tr_b16 a[92:93], v2 offset:10752
  ds_read_b64_tr_b16 a[94:95], v2 offset:11776
  s_waitcnt lgkmcnt(8)
  s_add_u32 m0, s52, 4096
  s_add_u32 s38, s45, 851968
  buffer_load_dwordx4 v3, s[16:19], s38 offen lds
  s_add_u32 m0, s52, 5120
  s_add_u32 s38, s45, 868352
  buffer_load_dwordx4 v3, s[16:19], s38 offen lds
  s_add_u32 m0, s52, 6144
  s_add_u32 s38, s45, 884736
  buffer_load_dwordx4 v3, s[16:19], s38 offen lds
  s_add_u32 m0, s52, 7168
  s_add_u32 s38, s45, 901120
  buffer_load_dwordx4 v3, s[16:19], s38 offen lds
  s_waitcnt vmcnt(28)
  ds_read_b64_tr_b16 a[96:97], v2 offset:12288
  ds_read_b64_tr_b16 a[98:99], v2 offset:13312
  ds_read_b64_tr_b16 a[104:105], v2 offset:14336
  ds_read_b64_tr_b16 a[106:107], v2 offset:15360
  ds_read_b64_tr_b16 a[100:101], v2 offset:12800
  ds_read_b64_tr_b16 a[102:103], v2 offset:13824
  ds_read_b64_tr_b16 a[108:109], v2 offset:14848
  ds_read_b64_tr_b16 a[110:111], v2 offset:15872
  s_waitcnt lgkmcnt(8)
  s_add_u32 m0, s52, 8192
  s_add_u32 s38, s45, 917504
  buffer_load_dwordx4 v3, s[16:19], s38 offen lds
  s_add_u32 m0, s52, 9216
  s_add_u32 s38, s45, 933888
  buffer_load_dwordx4 v3, s[16:19], s38 offen lds
  s_add_u32 m0, s52, 10240
  s_add_u32 s38, s45, 950272
  buffer_load_dwordx4 v3, s[16:19], s38 offen lds
  s_add_u32 m0, s52, 11264
  s_add_u32 s38, s45, 966656
  buffer_load_dwordx4 v3, s[16:19], s38 offen lds
  s_waitcnt vmcnt(28)
  ds_read_b64_tr_b16 a[112:113], v2 offset:16384
  ds_read_b64_tr_b16 a[114:115], v2 offset:17408
  ds_read_b64_tr_b16 a[120:121], v2 offset:18432
  ds_read_b64_tr_b16 a[122:123], v2 offset:19456
  ds_read_b64_tr_b16 a[116:117], v2 offset:16896
  ds_read_b64_tr_b16 a[118:119], v2 offset:17920
  ds_read_b64_tr_b16 a[124:125], v2 offset:18944
  ds_read_b64_tr_b16 a[126:127], v2 offset:19968
  s_waitcnt lgkmcnt(8)
  s_add_u32 m0, s52, 12288
  s_add_u32 s38, s45, 983040
  buffer_load_dwordx4 v3, s[16:19], s38 offen lds
  s_add_u32 m0, s52, 13312
  s_add_u32 s38, s45, 999424
  buffer_load_dwordx4 v3, s[16:19], s38 offen lds
  s_add_u32 m0, s52, 14336
  s_add_u32 s38, s45, 1015808
  buffer_load_dwordx4 v3, s[16:19], s38 offen lds
  s_add_u32 m0, s52, 15360
  s_add_u32 s38, s45, 1032192
  buffer_load_dwordx4 v3, s[16:19], s38 offen lds
  s_waitcnt vmcnt(28)
  ds_read_b64_tr_b16 a[128:129], v2 offset:20480
  ds_read_b64_tr_b16 a[130:131], v2 offset:21504
  ds_read_b64_tr_b16 a[136:137], v2 offset:22528
  ds_read_b64_tr_b16 a[138:139], v2 offset:23552
  ds_read_b64_tr_b16 a[132:133], v2 offset:20992
  ds_read_b64_tr_b16 a[134:135], v2 offset:22016
  ds_read_b64_tr_b16 a[140:141], v2 offset:23040
  ds_read_b64_tr_b16 a[142:143], v2 offset:24064
  s_waitcnt vmcnt(24)
  ds_read_b64_tr_b16 a[144:145], v2 offset:24576
  ds_read_b64_tr_b16 a[146:147], v2 offset:25600
  ds_read_b64_tr_b16 a[152:153], v2 offset:26624
  ds_read_b64_tr_b16 a[154:155], v2 offset:27648
  ds_read_b64_tr_b16 a[148:149], v2 offset:25088
  ds_read_b64_tr_b16 a[150:151], v2 offset:26112
  ds_read_b64_tr_b16 a[156:157], v2 offset:27136
  ds_read_b64_tr_b16 a[158:159], v2 offset:28160
  s_waitcnt vmcnt(20)
  ds_read_b64_tr_b16 a[160:161], v2 offset:28672
  ds_read_b64_tr_b16 a[162:163], v2 offset:29696
  ds_read_b64_tr_b16 a[168:169], v2 offset:30720
  ds_read_b64_tr_b16 a[170:171], v2 offset:31744
  ds_read_b64_tr_b16 a[164:165], v2 offset:29184
  ds_read_b64_tr_b16 a[166:167], v2 offset:30208
  ds_read_b64_tr_b16 a[172:173], v2 offset:31232
  ds_read_b64_tr_b16 a[174:175], v2 offset:32256
  s_waitcnt vmcnt(16)
  ds_read_b64_tr_b16 a[176:177], v2 offset:32768
  ds_read_b64_tr_b16 a[178:179], v2 offset:33792
  ds_read_b64_tr_b16 a[184:185], v2 offset:34816
  ds_read_b64_tr_b16 a[186:187], v2 offset:35840
  ds_read_b64_tr_b16 a[180:181], v2 offset:33280
  ds_read_b64_tr_b16 a[182:183], v2 offset:34304
  ds_read_b64_tr_b16 a[188:189], v2 offset:35328
  ds_read_b64_tr_b16 a[190:191], v2 offset:36352
  s_waitcnt vmcnt(12)
  ds_read_b64_tr_b16 a[192:193], v2 offset:0
  ds_read_b64_tr_b16 a[194:195], v2 offset:1024
  ds_read_b64_tr_b16 a[200:201], v2 offset:2048
  ds_read_b64_tr_b16 a[202:203], v2 offset:3072
  ds_read_b64_tr_b16 a[196:197], v2 offset:512
  ds_read_b64_tr_b16 a[198:199], v2 offset:1536
  ds_read_b64_tr_b16 a[204:205], v2 offset:2560
  ds_read_b64_tr_b16 a[206:207], v2 offset:3584
  s_waitcnt vmcnt(8)
  ds_read_b64_tr_b16 a[208:209], v2 offset:4096
  ds_read_b64_tr_b16 a[210:211], v2 offset:5120
  ds_read_b64_tr_b16 a[216:217], v2 offset:6144
  ds_read_b64_tr_b16 a[218:219], v2 offset:7168
  ds_read_b64_tr_b16 a[212:213], v2 offset:4608
  ds_read_b64_tr_b16 a[214:215], v2 offset:5632
  ds_read_b64_tr_b16 a[220:221], v2 offset:6656
  ds_read_b64_tr_b16 a[222:223], v2 offset:7680
  s_waitcnt vmcnt(4)
  ds_read_b64_tr_b16 a[224:225], v2 offset:8192
  ds_read_b64_tr_b16 a[226:227], v2 offset:9216
  ds_read_b64_tr_b16 a[232:233], v2 offset:10240
  ds_read_b64_tr_b16 a[234:235], v2 offset:11264
  ds_read_b64_tr_b16 a[228:229], v2 offset:8704
  ds_read_b64_tr_b16 a[230:231], v2 offset:9728
  ds_read_b64_tr_b16 a[236:237], v2 offset:10752
  ds_read_b64_tr_b16 a[238:239], v2 offset:11776
  s_waitcnt vmcnt(0)
  ds_read_b64_tr_b16 a[240:241], v2 offset:12288
  ds_read_b64_tr_b16 a[242:243], v2 offset:13312
  ds_read_b64_tr_b16 a[248:249], v2 offset:14336
  ds_read_b64_tr_b16 a[250:251], v2 offset:15360
  ds_read_b64_tr_b16 a[244:245], v2 offset:12800
  ds_read_b64_tr_b16 a[246:247], v2 offset:13824
  ds_read_b64_tr_b16 a[252:253], v2 offset:14848
  ds_read_b64_tr_b16 a[254:255], v2 offset:15872
  s_waitcnt lgkmcnt(0)
  s_barrier
  s_lshl_b32 s36, s32, 11
  v_add_u32 v4, s36, v0
  v_mov_b32 v12, v4
  v_and_b32 v21, 15, v1
  v_lshlrev_b32 v21, 10, v21
  v_lshrrev_b32 v22, 4, v1
  v_lshl_add_u32 v21, v22, 3, v21
  s_lshl_b32 s36, s48, 6
  s_lshl_b32 s37, s32, 5
  s_add_u32 s36, s36, s37
  v_add_u32 v5, s36, v21
  s_lshl_b32 s36, s32, 10
  v_add_u32 v6, s36, v0
  v_mov_b32 v9, 0
  v_and_b32 v7, 31, v1
  v_lshlrev_b32 v7, 10, v7
out_kv:
  buffer_load_dwordx4 v[32:35], v4, s[8:11], 0 offen sc1
  buffer_load_dwordx4 v[36:39], v4, s[8:11], 0 offen offset:1024 sc1
  s_waitcnt vmcnt(0)
  v_min3_u32 v8, v32, v33, v34
  v_min3_u32 v8, v8, v35, v36
  v_min3_u32 v8, v8, v37, v38
  v_min_u32 v8, v8, v39
  v_cmp_gt_u32 vcc, 4, v8
  s_cbranch_vccz out_top
  s_sleep 4
  s_sub_u32 s35, s35, 1
  s_cbranch_scc0 out_kv
  s_mov_b32 s35, 0
out_top:
  s_lshr_b32 s41, s40, 1
  s_lshl_b32 s42, s41, 7
  s_cmp_lg_u32 s32, 0
  s_cbranch_scc1 out_h_ok
  s_add_u32 s37, s42, 16384
out_h:
  buffer_load_dword v8, v9, s[8:11], s37 offen sc1
  s_waitcnt vmcnt(0)
  v_readfirstlane_b32 s39, v8
  s_nop 0
  s_and_b32 s36, s39, 0xffff
  s_cmp_ge_u32 s36, 43
  s_cbranch_scc1 out_h_ok
  s_sleep 2
  s_sub_u32 s35, s35, 1
  s_cbranch_scc0 out_h
  s_mov_b32 s35, 0
out_h_ok:
  s_barrier
  s_mul_i32 s43, s40, 45056
  s_add_u32 s43, s43, 83886080
  s_add_u32 s36, s32, 0
  s_min_u32 s36, s36, 42
  s_lshl_b32 s36, s36, 10
  s_add_u32 s36, s36, s43
  buffer_load_dwordx4 v[32:35], v0, s[8:11], s36 offen sc1
  s_add_u32 s36, s32, 4
  s_min_u32 s36, s36, 42
  s_lshl_b32 s36, s36, 10
  s_add_u32 s36, s36, s43
  buffer_load_dwordx4 v[36:39], v0, s[8:11], s36 offen sc1
  s_add_u32 s36, s32, 8
  s_min_u32 s36, s36, 42
  s_lshl_b32 s36, s36, 10
  s_add_u32 s36, s36, s43
  buffer_load_dwordx4 v[40:43], v0, s[8:11], s36 offen sc1
  s_add_u32 s36, s32, 12
  s_min_u32 s36, s36, 42
  s_lshl_b32 s36, s36, 10
  s_add_u32 s36, s36, s43
  buffer_load_dwordx4 v[44:47], v0, s[8:11], s36 offen sc1
  s_add_u32 s36, s32, 16
  s_min_u32 s36, s36, 42
  s_lshl_b32 s36, s36, 10
  s_add_u32 s36, s36, s43
  buffer_load_dwordx4 v[48:51], v0, s[8:11], s36 offen sc1
  s_add_u32 s36, s32, 20
  s_min_u32 s36, s36, 42
  s_lshl_b32 s36, s36, 10
  s_add_u32 s36, s36, s43
  buffer_load_dwordx4 v[52:55], v0, s[8:11], s36 offen sc1
  s_add_u32 s36, s32, 24
  s_min_u32 s36, s36, 42
  s_lshl_b32 s36, s36, 10
  s_add_u32 s36, s36, s43
  buffer_load_dwordx4 v[56:59], v0, s[8:11], s36 offen sc1
  s_add_u32 s36, s32, 28
  s_min_u32 s36, s36, 42
  s_lshl_b32 s36, s36, 10
  s_add_u32 s36, s36, s43
  buffer_load_dwordx4 v[60:63], v0, s[8:11], s36 offen sc1
  s_add_u32 s36, s32, 32
  s_min_u32 s36, s36, 42
  s_lshl_b32 s36, s36, 10
  s_add_u32 s36, s36, s43
  buffer_load_dwordx4 v[64:67], v0, s[8:11], s36 offen sc1
  s_add_u32 s36, s32, 36
  s_min_u32 s36, s36, 42
  s_lshl_b32 s36, s36, 10
  s_add_u32 s36, s36, s43
  buffer_load_dwordx4 v[68:71], v0, s[8:11], s36 offen sc1
  s_add_u32 s36, s32, 40
  s_min_u32 s36, s36, 42
  s_lshl_b32 s36, s36, 10
  s_add_u32 s36, s36, s43
  buffer_load_dwordx4 v[72:75], v0, s[8:11], s36 offen sc1
  s_lshl_b32 s44, s40, 14
  buffer_load_dwordx2 v[24:25], v5, s[28:31], s44 offen
  s_waitcnt vmcnt(11)
  v_mfma_f32_16x16x32_bf16 v[16:19], v[168:171], v[32:35], 0
  v_mfma_f32_16x16x32_bf16 v[20:23], v[172:175], v[32:35], 0
  s_waitcnt vmcnt(10)
  v_mfma_f32_16x16x32_bf16 v[16:19], v[176:179], v[36:39], v[16:19]
  v_mfma_f32_16x16x32_bf16 v[20:23], v[180:183], v[36:39], v[20:23]
  s_waitcnt vmcnt(9)
  v_mfma_f32_16x16x32_bf16 v[16:19], v[184:187], v[40:43], v[16:19]
  v_mfma_f32_16x16x32_bf16 v[20:23], v[188:191], v[40:43], v[20:23]
  s_waitcnt vmcnt(8)
  v_mfma_f32_16x16x32_bf16 v[16:19], v[192:195], v[44:47], v[16:19]
  v_mfma_f32_16x16x32_bf16 v[20:23], v[196:199], v[44:47], v[20:23]
  s_waitcnt vmcnt(7)
  v_mfma_f32_16x16x32_bf16 v[16:19], v[200:203], v[48:51], v[16:19]
  v_mfma_f32_16x16x32_bf16 v[20:23], v[204:207], v[48:51], v[20:23]
  s_waitcnt vmcnt(6)
  v_mfma_f32_16x16x32_bf16 v[16:19], v[208:211], v[52:55], v[16:19]
  v_mfma_f32_16x16x32_bf16 v[20:23], v[212:215], v[52:55], v[20:23]
  s_waitcnt vmcnt(5)
  v_mfma_f32_16x16x32_bf16 v[16:19], v[216:219], v[56:59], v[16:19]
  v_mfma_f32_16x16x32_bf16 v[20:23], v[220:223], v[56:59], v[20:23]
  s_waitcnt vmcnt(4)
  v_mfma_f32_16x16x32_bf16 v[16:19], v[224:227], v[60:63], v[16:19]
  v_mfma_f32_16x16x32_bf16 v[20:23], v[228:231], v[60:63], v[20:23]
  s_waitcnt vmcnt(3)
  v_mfma_f32_16x16x32_bf16 v[16:19], v[232:235], v[64:67], v[16:19]
  v_mfma_f32_16x16x32_bf16 v[20:23], v[236:239], v[64:67], v[20:23]
  s_waitcnt vmcnt(2)
  v_mfma_f32_16x16x32_bf16 v[16:19], v[240:243], v[68:71], v[16:19]
  v_mfma_f32_16x16x32_bf16 v[20:23], v[244:247], v[68:71], v[20:23]
  s_waitcnt vmcnt(1)
  v_mfma_f32_16x16x32_bf16 v[16:19], v[248:251], v[72:75], v[16:19]
  v_mfma_f32_16x16x32_bf16 v[20:23], v[252:255], v[72:75], v[20:23]
  s_lshl_b32 s43, s40, 17
  s_lshl_b32 s37, s32, 15
  s_add_u32 s43, s43, s37
  s_add_u32 s43, s43, 67108864
  s_cmp_ge_u32 s41, 58
  s_cbranch_scc1 out_late
  s_cmp_lg_u32 s32, 0
  s_cbranch_scc1 out_o_ok
  s_add_u32 s37, s42, 24576
out_o:
  buffer_load_dword v8, v9, s[8:11], s37 offen sc1
  s_waitcnt vmcnt(0)
  v_readfirstlane_b32 s39, v8
  s_nop 0
  s_and_b32 s36, s39, 0xffff
  s_cmp_ge_u32 s36, 32
  s_cbranch_scc1 out_o_ok
  s_sleep 12
  s_sub_u32 s35, s35, 1
  s_cbranch_scc0 out_o
  s_mov_b32 s35, 0
out_o_ok:
  s_barrier
  s_branch out_ld
out_late:
  s_cmp_lg_u32 s32, 0
  s_cbranch_scc1 out_g_ok
  s_lshl_b32 s37, s41, 13
  s_add_u32 s37, s37, 524288
out_g:
  buffer_load_dword v8, v9, s[8:11], s37 offen sc1
  s_waitcnt vmcnt(0)
  v_cmp_eq_u32 vcc, -1, v8
  s_cbranch_vccz out_g_ok
  s_sleep 12
  s_sub_u32 s35, s35, 1
  s_cbranch_scc0 out_g
  s_mov_b32 s35, 0
out_g_ok:
  s_barrier
out_can:
  buffer_load_dword v8, v7, s[8:11], s43 offen offset:1020 sc1
  s_waitcnt vmcnt(0)
  v_cmp_eq_u32 vcc, -1, v8
  s_cbranch_vccz out_ld
  s_sleep 1
  s_sub_u32 s35, s35, 1
  s_cbranch_scc0 out_can
  s_mov_b32 s35, 0
out_ld:
  s_mov_b32 s36, s43
  buffer_load_dwordx4 v[32:35], v0, s[8:11], s36 offen offset:0 sc1
  buffer_load_dwordx4 v[36:39], v0, s[8:11], s36 offen offset:1024 sc1
  buffer_load_dwordx4 v[40:43], v0, s[8:11], s36 offen offset:2048 sc1
  buffer_load_dwordx4 v[44:47], v0, s[8:11], s36 offen offset:3072 sc1
  s_add_u32 s36, s36, 4096
  buffer_load_dwordx4 v[48:51], v0, s[8:11], s36 offen offset:0 sc1
  buffer_load_dwordx4 v[52:55], v0, s[8:11], s36 offen offset:1024 sc1
  buffer_load_dwordx4 v[56:59], v0, s[8:11], s36 offen offset:2048 sc1
  buffer_load_dwordx4 v[60:63], v0, s[8:11], s36 offen offset:3072 sc1
  s_add_u32 s36, s36, 4096
  buffer_load_dwordx4 v[64:67], v0, s[8:11], s36 offen offset:0 sc1
  buffer_load_dwordx4 v[68:71], v0, s[8:11], s36 offen offset:1024 sc1
  buffer_load_dwordx4 v[72:75], v0, s[8:11], s36 offen offset:2048 sc1
  buffer_load_dwordx4 v[76:79], v0, s[8:11], s36 offen offset:3072 sc1
  s_add_u32 s36, s36, 4096
  buffer_load_dwordx4 v[80:83], v0, s[8:11], s36 offen offset:0 sc1
  buffer_load_dwordx4 v[84:87], v0, s[8:11], s36 offen offset:1024 sc1
  buffer_load_dwordx4 v[88:91], v0, s[8:11], s36 offen offset:2048 sc1
  buffer_load_dwordx4 v[92:95], v0, s[8:11], s36 offen offset:3072 sc1
  s_add_u32 s36, s36, 4096
  buffer_load_dwordx4 v[96:99], v0, s[8:11], s36 offen offset:0 sc1
  buffer_load_dwordx4 v[100:103], v0, s[8:11], s36 offen offset:1024 sc1
  buffer_load_dwordx4 v[104:107], v0, s[8:11], s36 offen offset:2048 sc1
  buffer_load_dwordx4 v[108:111], v0, s[8:11], s36 offen offset:3072 sc1
  s_add_u32 s36, s36, 4096
  buffer_load_dwordx4 v[112:115], v0, s[8:11], s36 offen offset:0 sc1
  buffer_load_dwordx4 v[116:119], v0, s[8:11], s36 offen offset:1024 sc1
  buffer_load_dwordx4 v[120:123], v0, s[8:11], s36 offen offset:2048 sc1
  buffer_load_dwordx4 v[124:127], v0, s[8:11], s36 offen offset:3072 sc1
  s_add_u32 s36, s36, 4096
  buffer_load_dwordx4 v[128:131], v0, s[8:11], s36 offen offset:0 sc1
  buffer_load_dwordx4 v[132:135], v0, s[8:11], s36 offen offset:1024 sc1
  buffer_load_dwordx4 v[136:139], v0, s[8:11], s36 offen offset:2048 sc1
  buffer_load_dwordx4 v[140:143], v0, s[8:11], s36 offen offset:3072 sc1
  s_add_u32 s36, s36, 4096
  buffer_load_dwordx4 v[144:147], v0, s[8:11], s36 offen offset:0 sc1
  buffer_load_dwordx4 v[148:151], v0, s[8:11], s36 offen offset:1024 sc1
  buffer_load_dwordx4 v[152:155], v0, s[8:11], s36 offen offset:2048 sc1
  buffer_load_dwordx4 v[156:159], v0, s[8:11], s36 offen offset:3072 sc1
  s_add_u32 s36, s36, 4096
  s_waitcnt vmcnt(31)
  v_mfma_f32_16x16x32_bf16 v[160:163], a[0:3], v[32:35], v[16:19]
  v_mfma_f32_16x16x32_bf16 v[164:167], a[4:7], v[32:35], v[20:23]
  s_waitcnt vmcnt(30)
  v_mfma_f32_16x16x32_bf16 v[160:163], a[8:11], v[36:39], v[160:163]
  v_mfma_f32_16x16x32_bf16 v[164:167], a[12:15], v[36:39], v[164:167]
  s_waitcnt vmcnt(29)
  v_mfma_f32_16x16x32_bf16 v[160:163], a[16:19], v[40:43], v[160:163]
  v_mfma_f32_16x16x32_bf16 v[164:167], a[20:23], v[40:43], v[164:167]
  s_waitcnt vmcnt(28)
  v_mfma_f32_16x16x32_bf16 v[160:163], a[24:27], v[44:47], v[160:163]
  v_mfma_f32_16x16x32_bf16 v[164:167], a[28:31], v[44:47], v[164:167]
  s_waitcnt vmcnt(27)
  v_mfma_f32_16x16x32_bf16 v[160:163], a[32:35], v[48:51], v[160:163]
  v_mfma_f32_16x16x32_bf16 v[164:167], a[36:39], v[48:51], v[164:167]
  s_waitcnt vmcnt(26)
  v_mfma_f32_16x16x32_bf16 v[160:163], a[40:43], v[52:55], v[160:163]
  v_mfma_f32_16x16x32_bf16 v[164:167], a[44:47], v[52:55], v[164:167]
  s_waitcnt vmcnt(25)
  v_mfma_f32_16x16x32_bf16 v[160:163], a[48:51], v[56:59], v[160:163]
  v_mfma_f32_16x16x32_bf16 v[164:167], a[52:55], v[56:59], v[164:167]
  s_waitcnt vmcnt(24)
  v_mfma_f32_16x16x32_bf16 v[160:163], a[56:59], v[60:63], v[160:163]
  v_mfma_f32_16x16x32_bf16 v[164:167], a[60:63], v[60:63], v[164:167]
  s_waitcnt vmcnt(23)
  v_mfma_f32_16x16x32_bf16 v[160:163], a[64:67], v[64:67], v[160:163]
  v_mfma_f32_16x16x32_bf16 v[164:167], a[68:71], v[64:67], v[164:167]
  s_waitcnt vmcnt(22)
  v_mfma_f32_16x16x32_bf16 v[160:163], a[72:75], v[68:71], v[160:163]
  v_mfma_f32_16x16x32_bf16 v[164:167], a[76:79], v[68:71], v[164:167]
  s_waitcnt vmcnt(21)
  v_mfma_f32_16x16x32_bf16 v[160:163], a[80:83], v[72:75], v[160:163]
  v_mfma_f32_16x16x32_bf16 v[164:167], a[84:87], v[72:75], v[164:167]
  s_waitcnt vmcnt(20)
  v_mfma_f32_16x16x32_bf16 v[160:163], a[88:91], v[76:79], v[160:163]
  v_mfma_f32_16x16x32_bf16 v[164:167], a[92:95], v[76:79], v[164:167]
  s_waitcnt vmcnt(19)
  v_mfma_f32_16x16x32_bf16 v[160:163], a[96:99], v[80:83], v[160:163]
  v_mfma_f32_16x16x32_bf16 v[164:167], a[100:103], v[80:83], v[164:167]
  s_waitcnt vmcnt(18)
  v_mfma_f32_16x16x32_bf16 v[160:163], a[104:107], v[84:87], v[160:163]
  v_mfma_f32_16x16x32_bf16 v[164:167], a[108:111], v[84:87], v[164:167]
  s_waitcnt vmcnt(17)
  v_mfma_f32_16x16x32_bf16 v[160:163], a[112:115], v[88:91], v[160:163]
  v_mfma_f32_16x16x32_bf16 v[164:167], a[116:119], v[88:91], v[164:167]
  s_waitcnt vmcnt(16)
  v_mfma_f32_16x16x32_bf16 v[160:163], a[120:123], v[92:95], v[160:163]
  v_mfma_f32_16x16x32_bf16 v[164:167], a[124:127], v[92:95], v[164:167]
  s_waitcnt vmcnt(15)
  v_mfma_f32_16x16x32_bf16 v[160:163], a[128:131], v[96:99], v[160:163]
  v_mfma_f32_16x16x32_bf16 v[164:167], a[132:135], v[96:99], v[164:167]
  s_waitcnt vmcnt(14)
  v_mfma_f32_16x16x32_bf16 v[160:163], a[136:139], v[100:103], v[160:163]
  v_mfma_f32_16x16x32_bf16 v[164:167], a[140:143], v[100:103], v[164:167]
  s_waitcnt vmcnt(13)
  v_mfma_f32_16x16x32_bf16 v[160:163], a[144:147], v[104:107], v[160:163]
  v_mfma_f32_16x16x32_bf16 v[164:167], a[148:151], v[104:107], v[164:167]
  s_waitcnt vmcnt(12)
  v_mfma_f32_16x16x32_bf16 v[160:163], a[152:155], v[108:111], v[160:163]
  v_mfma_f32_16x16x32_bf16 v[164:167], a[156:159], v[108:111], v[164:167]
  s_waitcnt vmcnt(11)
  v_mfma_f32_16x16x32_bf16 v[160:163], a[160:163], v[112:115], v[160:163]
  v_mfma_f32_16x16x32_bf16 v[164:167], a[164:167], v[112:115], v[164:167]
  s_waitcnt vmcnt(10)
  v_mfma_f32_16x16x32_bf16 v[160:163], a[168:171], v[116:119], v[160:163]
  v_mfma_f32_16x16x32_bf16 v[164:167], a[172:175], v[116:119], v[164:167]
  s_waitcnt vmcnt(9)
  v_mfma_f32_16x16x32_bf16 v[160:163], a[176:179], v[120:123], v[160:163]
  v_mfma_f32_16x16x32_bf16 v[164:167], a[180:183], v[120:123], v[164:167]
  s_waitcnt vmcnt(8)
  v_mfma_f32_16x16x32_bf16 v[160:163], a[184:187], v[124:127], v[160:163]
  v_mfma_f32_16x16x32_bf16 v[164:167], a[188:191], v[124:127], v[164:167]
  s_waitcnt vmcnt(7)
  v_mfma_f32_16x16x32_bf16 v[160:163], a[192:195], v[128:131], v[160:163]
  v_mfma_f32_16x16x32_bf16 v[164:167], a[196:199], v[128:131], v[164:167]
  s_waitcnt vmcnt(6)
  v_mfma_f32_16x16x32_bf16 v[160:163], a[200:203], v[132:135], v[160:163]
  v_mfma_f32_16x16x32_bf16 v[164:167], a[204:207], v[132:135], v[164:167]
  s_waitcnt vmcnt(5)
  v_mfma_f32_16x16x32_bf16 v[160:163], a[208:211], v[136:139], v[160:163]
  v_mfma_f32_16x16x32_bf16 v[164:167], a[212:215], v[136:139], v[164:167]
  s_waitcnt vmcnt(4)
  v_mfma_f32_16x16x32_bf16 v[160:163], a[216:219], v[140:143], v[160:163]
  v_mfma_f32_16x16x32_bf16 v[164:167], a[220:223], v[140:143], v[164:167]
  s_waitcnt vmcnt(3)
  v_mfma_f32_16x16x32_bf16 v[160:163], a[224:227], v[144:147], v[160:163]
  v_mfma_f32_16x16x32_bf16 v[164:167], a[228:231], v[144:147], v[164:167]
  s_waitcnt vmcnt(2)
  v_mfma_f32_16x16x32_bf16 v[160:163], a[232:235], v[148:151], v[160:163]
  v_mfma_f32_16x16x32_bf16 v[164:167], a[236:239], v[148:151], v[164:167]
  s_waitcnt vmcnt(1)
  v_mfma_f32_16x16x32_bf16 v[160:163], a[240:243], v[152:155], v[160:163]
  v_mfma_f32_16x16x32_bf16 v[164:167], a[244:247], v[152:155], v[164:167]
  s_waitcnt vmcnt(0)
  v_mfma_f32_16x16x32_bf16 v[160:163], a[248:251], v[156:159], v[160:163]
  v_mfma_f32_16x16x32_bf16 v[164:167], a[252:255], v[156:159], v[164:167]
  s_nop 6
  v_cmp_u_f32 vcc, v160, v160
  s_cbranch_vccz out_red
  v_max3_u32 v8, v32, v33, v33
  v_max3_u32 v8, v8, v34, v35
  v_max3_u32 v8, v8, v36, v37
  v_max3_u32 v8, v8, v38, v39
  v_max3_u32 v8, v8, v40, v41
  v_max3_u32 v8, v8, v42, v43
  v_max3_u32 v8, v8, v44, v45
  v_max3_u32 v8, v8, v46, v47
  v_max3_u32 v8, v8, v48, v49
  v_max3_u32 v8, v8, v50, v51
  v_max3_u32 v8, v8, v52, v53
  v_max3_u32 v8, v8, v54, v55
  v_max3_u32 v8, v8, v56, v57
  v_max3_u32 v8, v8, v58, v59
  v_max3_u32 v8, v8, v60, v61
  v_max3_u32 v8, v8, v62, v63
  v_max3_u32 v8, v8, v64, v65
  v_max3_u32 v8, v8, v66, v67
  v_max3_u32 v8, v8, v68, v69
  v_max3_u32 v8, v8, v70, v71
  v_max3_u32 v8, v8, v72, v73
  v_max3_u32 v8, v8, v74, v75
  v_max3_u32 v8, v8, v76, v77
  v_max3_u32 v8, v8, v78, v79
  v_max3_u32 v8, v8, v80, v81
  v_max3_u32 v8, v8, v82, v83
  v_max3_u32 v8, v8, v84, v85
  v_max3_u32 v8, v8, v86, v87
  v_max3_u32 v8, v8, v88, v89
  v_max3_u32 v8, v8, v90, v91
  v_max3_u32 v8, v8, v92, v93
  v_max3_u32 v8, v8, v94, v95
  v_max3_u32 v8, v8, v96, v97
  v_max3_u32 v8, v8, v98, v99
  v_max3_u32 v8, v8, v100, v101
  v_max3_u32 v8, v8, v102, v103
  v_max3_u32 v8, v8, v104, v105
  v_max3_u32 v8, v8, v106, v107
  v_max3_u32 v8, v8, v108, v109
  v_max3_u32 v8, v8, v110, v111
  v_max3_u32 v8, v8, v112, v113
  v_max3_u32 v8, v8, v114, v115
  v_max3_u32 v8, v8, v116, v117
  v_max3_u32 v8, v8, v118, v119
  v_max3_u32 v8, v8, v120, v121
  v_max3_u32 v8, v8, v122, v123
  v_max3_u32 v8, v8, v124, v125
  v_max3_u32 v8, v8, v126, v127
  v_max3_u32 v8, v8, v128, v129
  v_max3_u32 v8, v8, v130, v131
  v_max3_u32 v8, v8, v132, v133
  v_max3_u32 v8, v8, v134, v135
  v_max3_u32 v8, v8, v136, v137
  v_max3_u32 v8, v8, v138, v139
  v_max3_u32 v8, v8, v140, v141
  v_max3_u32 v8, v8, v142, v143
  v_max3_u32 v8, v8, v144, v145
  v_max3_u32 v8, v8, v146, v147
  v_max3_u32 v8, v8, v148, v149
  v_max3_u32 v8, v8, v150, v151
  v_max3_u32 v8, v8, v152, v153
  v_max3_u32 v8, v8, v154, v155
  v_max3_u32 v8, v8, v156, v157
  v_max3_u32 v8, v8, v158, v159
  v_cmp_eq_u32 vcc, -1, v8
  s_cbranch_vccz out_red
  s_sub_u32 s35, s35, 1
  s_cbranch_scc0 out_ld
  s_mov_b32 s35, 0
out_red:
  ds_write_b128 v12, v[160:163]
  ds_write_b128 v12, v[164:167] offset:1024
  s_waitcnt lgkmcnt(0)
  s_barrier
  s_cmp_ge_u32 s32, 2
  s_cbranch_scc1 out_next
  ds_read_b128 v[32:35], v6 offset:0
  ds_read_b128 v[36:39], v6 offset:2048
  ds_read_b128 v[40:43], v6 offset:4096
  ds_read_b128 v[44:47], v6 offset:6144
  v_lshlrev_b32 v26, 16, v24
  v_and_b32 v27, 0xffff0000, v24
  v_lshlrev_b32 v28, 16, v25
  v_and_b32 v29, 0xffff0000, v25
  s_waitcnt lgkmcnt(0)
  v_add_f32 v32, v32, v36
  v_add_f32 v40, v40, v44
  v_add_f32 v33, v33, v37
  v_add_f32 v41, v41, v45
  v_add_f32 v34, v34, v38
  v_add_f32 v42, v42, v46
  v_add_f32 v35, v35, v39
  v_add_f32 v43, v43, v47
  v_add_f32 v32, v32, v40
  v_add_f32 v32, v32, v26
  v_add_f32 v33, v33, v41
  v_add_f32 v33, v33, v27
  v_add_f32 v34, v34, v42
  v_add_f32 v34, v34, v28
  v_add_f32 v35, v35, v43
  v_add_f32 v35, v35, v29
  v_cvt_pk_bf16_f32 v30, v32, v33
  v_cvt_pk_bf16_f32 v31, v34, v35
  buffer_store_dwordx2 v[30:31], v5, s[24:27], s44 offen nt
out_next:
  v_xor_b32 v12, 0x2000, v12
  v_xor_b32 v6, 0x2000, v6
  s_add_u32 s40, s40, 8
  s_cmp_lt_u32 s40, 128
  s_cbranch_scc1 out_top
L_end:
  s_endpgm
.section .rodata,"a"
.p2align 6

.amdhsa_kernel parallel_sum__memory_aug_recurrent_mem_tr__geglu_ffn__prompt_kernel
  .amdhsa_next_free_vgpr 512
  .amdhsa_next_free_sgpr 102
  .amdhsa_accum_offset 256
  .amdhsa_group_segment_fixed_size 0
  .amdhsa_kernarg_size 112
  .amdhsa_user_sgpr_count 2
  .amdhsa_user_sgpr_kernarg_segment_ptr 1
  .amdhsa_system_sgpr_workgroup_id_x 1
.end_amdhsa_kernel
```
